```python
import torch

def _softmax(x, axis=-1):
    return torch.softmax(x, dim=axis)
def _gelu(x):
    return torch.nn.functional.gelu(x, approximate="tanh")
def _silu(x):
    return torch.nn.functional.silu(x)
def _sigmoid(x):
    return torch.sigmoid(x)
def _layernorm(x, axis=-1, eps=1e-5):
    m = x.mean(dim=axis, keepdim=True)
    v = x.var(dim=axis, keepdim=True, unbiased=False)
    return (x - m) / torch.sqrt(v + eps)
def _scatter_add(tgt, idx, src, axis=0):
    return tgt.clone().index_add_(axis, idx, src)
def _segment_sum(src, seg, n):
    out = torch.zeros((n,) + src.shape[1:], dtype=src.dtype)
    return out.index_add_(0, seg, src)
def _pad(x, pw):
    flat = tuple(v for pair in reversed(pw) for v in pair)
    return torch.nn.functional.pad(x, flat)

kernel_name = 'interleave_layers__mha_block_cached__dense_activation_gelu__decode'

def setup_inputs():

    _w = (lambda a: (lambda t: t.to(torch.bfloat16) if t.is_floating_point() else t)(torch.as_tensor(a)))
    def _A_setup():
        B, Sq, D = 2, 1, 576
        H, Sk, Dh = 32, 8192, 128
        return {
            "x": _w((lambda *s: torch.randn(*s, dtype=torch.bfloat16) * 0.1)(B, Sq, D)),
            "k_cache": _w((lambda *s: torch.randn(*s, dtype=torch.bfloat16) * 0.8)(B, H, Sk, Dh)),
            "v_cache": _w((lambda *s: torch.randn(*s, dtype=torch.bfloat16) * 3.2)(B, H, Sk, Dh)),
            "wq": _w((lambda *s: torch.randn(*s, dtype=torch.bfloat16) * 0.8)(D, H * Dh) * (D ** -0.5)),
            "wo": _w((lambda *s: torch.randn(*s, dtype=torch.bfloat16) * 3.2)(H * Dh, D) * ((H * Dh) ** -0.5)),
        }
    _A_in = _A_setup()

    def _B_setup():
        B, S, D, F = 2, 1, 576, 4608
        return {
            "x": _w((lambda *s: torch.randn(*s, dtype=torch.bfloat16) * 0.1)(B, S, D)),
            "w1": _w((lambda *s: torch.randn(*s, dtype=torch.bfloat16) * 1.6)(D, F) * (D ** -0.5)),
            "b1": _w((lambda *s: torch.randn(*s, dtype=torch.bfloat16) * 1.6)(F) * 0.01),
            "w2": _w((lambda *s: torch.randn(*s, dtype=torch.bfloat16) * 0.4)(F, D) * (F ** -0.5)),
            "b2": _w((lambda *s: torch.randn(*s, dtype=torch.bfloat16) * 0.4)(D) * 0.01),
        }
    _B_in = _B_setup()

    return {
        "A_x": _A_in["x"],
        "A_k_cache": _A_in["k_cache"],
        "A_v_cache": _A_in["v_cache"],
        "A_wq": _A_in["wq"],
        "A_wo": _A_in["wo"],
        "B_x": _B_in["x"],
        "B_w1": _B_in["w1"],
        "B_b1": _B_in["b1"],
        "B_w2": _B_in["w2"],
        "B_b2": _B_in["b2"],
    }

def reference(A_x, A_k_cache, A_v_cache, A_wq, A_wo, B_x, B_w1, B_b1, B_w2, B_b2):
    def _A_ref(x, k_cache, v_cache, wq, wo):
        B, Sq, D = x.shape
        H, Dh = 32, 128
        q = (lambda x, *d: x.permute(*d))((x @ wq).reshape(B, Sq, H, Dh), 0, 2, 1, 3)
        scores = torch.einsum("bhqd,bhkd->bhqk", q, k_cache) * (Dh ** -0.5)
        p = _softmax(scores, axis=-1)
        o = torch.einsum("bhqk,bhkd->bhqd", p, v_cache)
        return (lambda x, *d: x.permute(*d))(o, 0, 2, 1, 3).reshape(B, Sq, H * Dh) @ wo

    def _B_ref(x, w1, b1, w2, b2):
        h = torch.einsum("bsd,df->bsf", x, w1) + b1
        h = _gelu(h)
        return torch.einsum("bsf,fd->bsd", h, w2) + b2

    x = A_x
    x = x + _A_ref(_layernorm(x, axis=-1), A_k_cache, A_v_cache, A_wq, A_wo)
    x = x + _B_ref(_layernorm(x, axis=-1), B_w1, B_b1, B_w2, B_b2)
    x = x + _A_ref(_layernorm(x, axis=-1), A_k_cache, A_v_cache, A_wq, A_wo)
    x = x + _B_ref(_layernorm(x, axis=-1), B_w1, B_b1, B_w2, B_b2)
    return x
```

```asm
; @launch grid=(256,1,1) block=(256,1,1) lds=163840
.amdgcn_target "amdgcn-amd-amdhsa--gfx950"
.text
.globl interleave_layers__mha_block_cached__dense_activation_gelu__decode_kernel
.p2align 8
.type interleave_layers__mha_block_cached__dense_activation_gelu__decode_kernel,@function
interleave_layers__mha_block_cached__dense_activation_gelu__decode_kernel:
  s_cmp_ge_u32 s2, 256
  s_cbranch_scc1 L_exit
  s_load_dwordx16 s[56:71], s[0:1], 0
  s_load_dwordx8 s[72:79], s[0:1], 64
  s_load_dwordx2 s[80:81], s[0:1], 96
  v_lshrrev_b32 v1, 6, v0
  s_nop 0
  v_readfirstlane_b32 s3, v1
  v_and_b32 v0, 63, v0
  s_and_b32 s4, s2, 7
  s_cmp_eq_u32 s4, 7
  s_nop 0
  s_cbranch_scc1 L_chain
  s_lshr_b32 s32, s2, 3
  s_and_b32 s33, s2, 7
  s_cmp_gt_u32 s33, 7
  s_subb_u32 s33, s33, 0
  s_lshl_b32 s50, s33, 2
  s_add_u32 s50, s50, s3
  s_cmp_eq_u32 s3, 0
  s_cselect_b32 s27, 1, 0
  s_cmp_eq_u32 s50, 1
  s_cselect_b32 s27, 1, s27
  s_mul_i32 s51, s50, 18
  s_add_u32 s52, s50, 3
  s_lshr_b32 s52, s52, 2
  s_add_u32 s51, s51, s52
  s_cmp_ge_u32 s50, 2
  s_addc_u32 s51, s51, 0
  s_add_u32 s51, s51, s27
  s_sub_u32 s51, s51, 1
  s_lshl_b32 s51, s51, 12
  s_lshl_b32 s24, s32, 21
  s_add_u32 s24, s24, s51
  s_mul_i32 s25, s3, 40960
  s_cmp_ge_u32 s3, 2
  s_cselect_b32 s52, 8192, 0
  s_sub_u32 s25, s25, s52
  s_cmp_eq_u32 s3, 3
  s_cselect_b32 s52, 8192, 0
  s_sub_u32 s25, s25, s52
  v_and_b32 v11, 15, v0
  v_lshrrev_b32 v10, 4, v0
  v_and_b32 v1, 3, v11
  v_lshlrev_b32 v1, 2, v1
  v_bfe_u32 v2, v11, 2, 1
  v_add_u32 v1, v1, v2
  v_lshlrev_b32 v1, 8, v1
  v_lshrrev_b32 v2, 3, v11
  v_lshlrev_b32 v2, 6, v2
  v_lshl_add_u32 v2, v10, 4, v2
  v_add_u32 v1, v1, v2
  v_lshlrev_b32 v2, 4, v0
  v_add_u32 v3, s25, v2
  s_waitcnt lgkmcnt(0)
  s_mov_b32 s8, s58
  s_and_b32 s9, s59, 0xffff
  s_mov_b32 s10, 0x8000000
  s_mov_b32 s11, 0x20000
  s_cmp_eq_u32 s3, 1
  s_cbranch_scc0 Lcp_1
  s_getpc_b64 s[50:51]
Lpc_2:
  s_add_u32 s50, s50, L_attn_rest-Lpc_2
  s_addc_u32 s51, s51, 0
  s_mov_b32 s52, L_chain-L_attn_rest-4
  v_lshlrev_b32 v11, 7, v0
  v_min_u32 v11, s52, v11
  global_load_dword v56, v11, s[50:51]
  v_lshlrev_b32 v11, 7, v0
  v_add_u32 v11, 8192, v11
  v_min_u32 v11, s52, v11
  global_load_dword v57, v11, s[50:51]
Lcp_1:
  v_and_b32 v11, 15, v0
  s_cmp_eq_u32 s27, 0
  s_cbranch_scc1 Lopt_3
  s_add_u32 s28, s24, 0
  s_add_u32 m0, s25, 0
  s_add_u32 s51, s28, 0
  buffer_load_dwordx4 v1, s[8:11], s51 offen nt lds
  s_add_u32 m0, s25, 1024
  s_add_u32 s51, s28, 128
  buffer_load_dwordx4 v1, s[8:11], s51 offen nt lds
  s_add_u32 m0, s25, 2048
  s_add_u32 s51, s28, 512
  buffer_load_dwordx4 v1, s[8:11], s51 offen nt lds
  s_add_u32 m0, s25, 3072
  s_add_u32 s51, s28, 640
  buffer_load_dwordx4 v1, s[8:11], s51 offen nt lds
Lopt_3:
  s_add_u32 s28, s24, 4096
  s_waitcnt vmcnt(3)
  s_add_u32 m0, s25, 8192
  s_add_u32 s51, s28, 0
  buffer_load_dwordx4 v1, s[8:11], s51 offen nt lds
  s_waitcnt vmcnt(3)
  s_add_u32 m0, s25, 9216
  s_add_u32 s51, s28, 128
  buffer_load_dwordx4 v1, s[8:11], s51 offen nt lds
  s_waitcnt vmcnt(3)
  s_add_u32 m0, s25, 10240
  s_add_u32 s51, s28, 512
  buffer_load_dwordx4 v1, s[8:11], s51 offen nt lds
  s_waitcnt vmcnt(3)
  s_add_u32 m0, s25, 11264
  s_add_u32 s51, s28, 640
  buffer_load_dwordx4 v1, s[8:11], s51 offen nt lds
  s_add_u32 s28, s24, 8192
  s_waitcnt vmcnt(3)
  s_add_u32 m0, s25, 16384
  s_add_u32 s51, s28, 0
  buffer_load_dwordx4 v1, s[8:11], s51 offen nt lds
  s_waitcnt vmcnt(3)
  s_add_u32 m0, s25, 17408
  s_add_u32 s51, s28, 128
  buffer_load_dwordx4 v1, s[8:11], s51 offen nt lds
  s_waitcnt vmcnt(3)
  s_add_u32 m0, s25, 18432
  s_add_u32 s51, s28, 512
  buffer_load_dwordx4 v1, s[8:11], s51 offen nt lds
  s_waitcnt vmcnt(3)
  s_add_u32 m0, s25, 19456
  s_add_u32 s51, s28, 640
  buffer_load_dwordx4 v1, s[8:11], s51 offen nt lds
  s_add_u32 s28, s24, 12288
  s_waitcnt vmcnt(3)
  s_add_u32 m0, s25, 24576
  s_add_u32 s51, s28, 0
  buffer_load_dwordx4 v1, s[8:11], s51 offen nt lds
  s_waitcnt vmcnt(3)
  s_add_u32 m0, s25, 25600
  s_add_u32 s51, s28, 128
  buffer_load_dwordx4 v1, s[8:11], s51 offen nt lds
  s_waitcnt vmcnt(3)
  s_add_u32 m0, s25, 26624
  s_add_u32 s51, s28, 512
  buffer_load_dwordx4 v1, s[8:11], s51 offen nt lds
  s_waitcnt vmcnt(3)
  s_add_u32 m0, s25, 27648
  s_add_u32 s51, s28, 640
  buffer_load_dwordx4 v1, s[8:11], s51 offen nt lds
L_attn_rest:
  s_mov_b32 s12, s60
  s_and_b32 s13, s61, 0xffff
  s_mov_b32 s14, 0x8000000
  s_mov_b32 s15, 0x20000
  s_mov_b32 s16, s80
  s_and_b32 s17, s81, 0xffff
  s_mov_b32 s18, 0x200000
  s_mov_b32 s19, 0x20000
  s_mov_b32 s20, s78
  s_and_b32 s21, s79, 0xffff
  s_mov_b32 s22, 0x100
  s_mov_b32 s23, 0x20000
  s_mov_b64 s[4:5], s[80:81]
  s_mov_b64 s[6:7], s[78:79]
  v_lshlrev_b32 v10, 4, v11
  v_mov_b32 v4, 63
  v_cmp_gt_u32 vcc, 4, v11
  s_nop 1
  v_cndmask_b32 v4, v4, v10, vcc
  v_subrev_u32 v10, 64, v10
  v_mov_b32 v5, 63
  v_cmp_gt_u32 vcc, 64, v10
  s_nop 1
  v_cndmask_b32 v5, v5, v10, vcc
  v_mov_b32 v7, 0
  v_mov_b32 v9, 0
  s_mov_b32 s55, 0x3e0293ee
  s_mov_b32 s56, 0x10001
  s_mov_b32 s57, 0x1000100
  s_mov_b32 s58, 0x1000100
  s_mov_b32 s59, 0x10001
  s_mov_b32 s60, 0x20002
  s_mov_b32 s61, 0x2000200
  s_mov_b32 s62, 0x2000200
  s_mov_b32 s63, 0x20002
  s_mov_b32 s64, 0x40004
  s_mov_b32 s65, 0x4000400
  s_mov_b32 s66, 0x4000400
  s_mov_b32 s67, 0x40004
  s_mov_b32 s68, 0x80008
  s_mov_b32 s69, 0x8000800
  s_mov_b32 s70, 0x8000800
  s_mov_b32 s71, 0x80008
  s_mov_b32 s72, 0x100010
  s_mov_b32 s73, 0x10001000
  s_mov_b32 s74, 0x10001000
  s_mov_b32 s75, 0x100010
  s_mov_b32 s76, 0x200020
  s_mov_b32 s77, 0x20002000
  s_mov_b32 s78, 0x20002000
  s_mov_b32 s79, 0x200020
  s_mov_b32 s80, 0x400040
  s_mov_b32 s81, 0x40004000
  s_mov_b32 s82, 0x40004000
  s_mov_b32 s83, 0x400040
  s_mov_b32 s84, 0x800080
  s_mov_b32 s85, 0x80008000
  s_mov_b32 s86, 0x80008000
  s_mov_b32 s87, 0x800080
  s_lshl_b32 s30, s32, 3
  s_add_u32 s30, s30, s33
  s_mul_i32 s30, s30, 640
  s_cmp_eq_u32 s3, 3
  s_cbranch_scc0 Lclr_4
  v_mov_b32 v12, -1
  v_mov_b32 v13, -1
  v_mov_b32 v14, -1
  v_mov_b32 v15, -1
  s_mov_b32 exec_hi, 1
  s_add_u32 s28, s30, 0
  buffer_store_dwordx4 v[12:15], v2, s[16:19], s28 offen sc0 sc1
  s_add_u32 s28, s30, 163840
  buffer_store_dwordx4 v[12:15], v2, s[16:19], s28 offen sc0 sc1
  s_add_u32 s28, s30, 327680
  buffer_store_dwordx4 v[12:15], v2, s[16:19], s28 offen sc0 sc1
  s_add_u32 s28, s30, 491520
  buffer_store_dwordx4 v[12:15], v2, s[16:19], s28 offen sc0 sc1
  s_mov_b64 exec, -1
  s_waitcnt vmcnt(0)
  v_mov_b32 v12, 1
  v_mov_b32 v13, 0
  s_mov_b64 exec, 1
  buffer_atomic_add v12, v13, s[20:23], 0 offen sc1
  s_mov_b64 exec, -1
Lclr_4:
  s_add_u32 s28, s24, 16384
  s_waitcnt vmcnt(3)
  s_add_u32 m0, s25, 32768
  s_add_u32 s51, s28, 0
  buffer_load_dwordx4 v1, s[8:11], s51 offen nt lds
  s_waitcnt vmcnt(3)
  s_add_u32 m0, s25, 33792
  s_add_u32 s51, s28, 128
  buffer_load_dwordx4 v1, s[8:11], s51 offen nt lds
  s_waitcnt vmcnt(3)
  s_add_u32 m0, s25, 34816
  s_add_u32 s51, s28, 512
  buffer_load_dwordx4 v1, s[8:11], s51 offen nt lds
  s_waitcnt vmcnt(3)
  s_add_u32 m0, s25, 35840
  s_add_u32 s51, s28, 640
  buffer_load_dwordx4 v1, s[8:11], s51 offen nt lds
  s_add_u32 s28, s24, 20480
  s_waitcnt vmcnt(3)
  buffer_load_dwordx4 a[0:3], v1, s[8:11], s28 offen offset:0 nt
  s_waitcnt vmcnt(3)
  buffer_load_dwordx4 a[4:7], v1, s[8:11], s28 offen offset:128 nt
  s_waitcnt vmcnt(3)
  buffer_load_dwordx4 a[8:11], v1, s[8:11], s28 offen offset:512 nt
  s_waitcnt vmcnt(3)
  buffer_load_dwordx4 a[12:15], v1, s[8:11], s28 offen offset:640 nt
  s_add_u32 s28, s24, 24576
  s_waitcnt vmcnt(3)
  buffer_load_dwordx4 a[16:19], v1, s[8:11], s28 offen offset:0 nt
  s_waitcnt vmcnt(3)
  buffer_load_dwordx4 a[20:23], v1, s[8:11], s28 offen offset:128 nt
  s_waitcnt vmcnt(3)
  buffer_load_dwordx4 a[24:27], v1, s[8:11], s28 offen offset:512 nt
  s_waitcnt vmcnt(3)
  buffer_load_dwordx4 a[28:31], v1, s[8:11], s28 offen offset:640 nt
  s_add_u32 s28, s24, 28672
  s_waitcnt vmcnt(3)
  buffer_load_dwordx4 a[32:35], v1, s[8:11], s28 offen offset:0 nt
  s_waitcnt vmcnt(3)
  buffer_load_dwordx4 a[36:39], v1, s[8:11], s28 offen offset:128 nt
  s_waitcnt vmcnt(3)
  buffer_load_dwordx4 a[40:43], v1, s[8:11], s28 offen offset:512 nt
  s_waitcnt vmcnt(3)
  buffer_load_dwordx4 a[44:47], v1, s[8:11], s28 offen offset:640 nt
  s_add_u32 s28, s24, 32768
  s_waitcnt vmcnt(3)
  buffer_load_dwordx4 a[48:51], v1, s[8:11], s28 offen offset:0 nt
  s_waitcnt vmcnt(3)
  buffer_load_dwordx4 a[52:55], v1, s[8:11], s28 offen offset:128 nt
  s_waitcnt vmcnt(3)
  buffer_load_dwordx4 a[56:59], v1, s[8:11], s28 offen offset:512 nt
  s_waitcnt vmcnt(3)
  buffer_load_dwordx4 a[60:63], v1, s[8:11], s28 offen offset:640 nt
  s_add_u32 s28, s24, 36864
  s_waitcnt vmcnt(3)
  buffer_load_dwordx4 a[64:67], v1, s[8:11], s28 offen offset:0 nt
  s_waitcnt vmcnt(3)
  buffer_load_dwordx4 a[68:71], v1, s[8:11], s28 offen offset:128 nt
  s_waitcnt vmcnt(3)
  buffer_load_dwordx4 a[72:75], v1, s[8:11], s28 offen offset:512 nt
  s_waitcnt vmcnt(3)
  buffer_load_dwordx4 a[76:79], v1, s[8:11], s28 offen offset:640 nt
  s_add_u32 s28, s24, 40960
  s_waitcnt vmcnt(3)
  buffer_load_dwordx4 a[80:83], v1, s[8:11], s28 offen offset:0 nt
  s_waitcnt vmcnt(3)
  buffer_load_dwordx4 a[84:87], v1, s[8:11], s28 offen offset:128 nt
  s_waitcnt vmcnt(3)
  buffer_load_dwordx4 a[88:91], v1, s[8:11], s28 offen offset:512 nt
  s_waitcnt vmcnt(3)
  buffer_load_dwordx4 a[92:95], v1, s[8:11], s28 offen offset:640 nt
  s_add_u32 s28, s24, 45056
  s_waitcnt vmcnt(3)
  buffer_load_dwordx4 a[96:99], v1, s[8:11], s28 offen offset:0 nt
  s_waitcnt vmcnt(3)
  buffer_load_dwordx4 a[100:103], v1, s[8:11], s28 offen offset:128 nt
  s_waitcnt vmcnt(3)
  buffer_load_dwordx4 a[104:107], v1, s[8:11], s28 offen offset:512 nt
  s_waitcnt vmcnt(3)
  buffer_load_dwordx4 a[108:111], v1, s[8:11], s28 offen offset:640 nt
  s_add_u32 s28, s24, 49152
  s_waitcnt vmcnt(3)
  buffer_load_dwordx4 a[112:115], v1, s[8:11], s28 offen offset:0 nt
  s_waitcnt vmcnt(3)
  buffer_load_dwordx4 a[116:119], v1, s[8:11], s28 offen offset:128 nt
  s_waitcnt vmcnt(3)
  buffer_load_dwordx4 a[120:123], v1, s[8:11], s28 offen offset:512 nt
  s_waitcnt vmcnt(3)
  buffer_load_dwordx4 a[124:127], v1, s[8:11], s28 offen offset:640 nt
  s_add_u32 s28, s24, 53248
  s_waitcnt vmcnt(3)
  buffer_load_dwordx4 a[128:131], v1, s[8:11], s28 offen offset:0 nt
  s_waitcnt vmcnt(3)
  buffer_load_dwordx4 a[132:135], v1, s[8:11], s28 offen offset:128 nt
  s_waitcnt vmcnt(3)
  buffer_load_dwordx4 a[136:139], v1, s[8:11], s28 offen offset:512 nt
  s_waitcnt vmcnt(3)
  buffer_load_dwordx4 a[140:143], v1, s[8:11], s28 offen offset:640 nt
  s_add_u32 s28, s24, 57344
  s_waitcnt vmcnt(3)
  buffer_load_dwordx4 a[144:147], v1, s[8:11], s28 offen offset:0 nt
  s_waitcnt vmcnt(3)
  buffer_load_dwordx4 a[148:151], v1, s[8:11], s28 offen offset:128 nt
  s_waitcnt vmcnt(3)
  buffer_load_dwordx4 a[152:155], v1, s[8:11], s28 offen offset:512 nt
  s_waitcnt vmcnt(3)
  buffer_load_dwordx4 a[156:159], v1, s[8:11], s28 offen offset:640 nt
  v_mov_b32 v12, 128
  buffer_load_dwordx2 v[10:11], v12, s[20:23], 0 offen sc1
  s_add_u32 s28, s24, 61440
  s_waitcnt vmcnt(3)
  buffer_load_dwordx4 a[160:163], v1, s[8:11], s28 offen offset:0 nt
  s_waitcnt vmcnt(3)
  buffer_load_dwordx4 a[164:167], v1, s[8:11], s28 offen offset:128 nt
  s_waitcnt vmcnt(3)
  buffer_load_dwordx4 a[168:171], v1, s[8:11], s28 offen offset:512 nt
  s_waitcnt vmcnt(3)
  buffer_load_dwordx4 a[172:175], v1, s[8:11], s28 offen offset:640 nt
  s_add_u32 s28, s24, 65536
  s_waitcnt vmcnt(3)
  buffer_load_dwordx4 a[176:179], v1, s[8:11], s28 offen offset:0 nt
  s_waitcnt vmcnt(3)
  buffer_load_dwordx4 a[180:183], v1, s[8:11], s28 offen offset:128 nt
  s_waitcnt vmcnt(3)
  buffer_load_dwordx4 a[184:187], v1, s[8:11], s28 offen offset:512 nt
  s_waitcnt vmcnt(3)
  buffer_load_dwordx4 a[188:191], v1, s[8:11], s28 offen offset:640 nt
  s_add_u32 s28, s24, 69632
  s_waitcnt vmcnt(3)
  buffer_load_dwordx4 a[192:195], v1, s[8:11], s28 offen offset:0 nt
  s_waitcnt vmcnt(3)
  buffer_load_dwordx4 a[196:199], v1, s[8:11], s28 offen offset:128 nt
  s_waitcnt vmcnt(3)
  buffer_load_dwordx4 a[200:203], v1, s[8:11], s28 offen offset:512 nt
  s_waitcnt vmcnt(3)
  buffer_load_dwordx4 a[204:207], v1, s[8:11], s28 offen offset:640 nt
  s_add_u32 s28, s24, 73728
  s_waitcnt vmcnt(3)
  buffer_load_dwordx4 a[208:211], v1, s[8:11], s28 offen offset:0 nt
  s_waitcnt vmcnt(3)
  buffer_load_dwordx4 a[212:215], v1, s[8:11], s28 offen offset:128 nt
  s_waitcnt vmcnt(3)
  buffer_load_dwordx4 a[216:219], v1, s[8:11], s28 offen offset:512 nt
  s_waitcnt vmcnt(3)
  buffer_load_dwordx4 a[220:223], v1, s[8:11], s28 offen offset:640 nt
  s_waitcnt vmcnt(4)
  s_mov_b32 s34, 0
Lcsp_6:
  v_sad_u8 v10, v10, 0, 0
  v_sad_u8 v10, v11, 0, v10
  s_nop 0
  v_readfirstlane_b32 s52, v10
  s_nop 0
  s_cmp_ge_u32 s52, 32
  s_nop 1
  s_cbranch_scc1 Lcok_5
  buffer_load_dwordx2 v[10:11], v12, s[20:23], 0 offen sc1
  s_waitcnt vmcnt(0)
  s_add_u32 s34, s34, 1
  s_cmp_lt_u32 s34, 20000
  s_cbranch_scc1 Lcsp_6
Lcok_5:
  s_cmp_eq_u32 s27, 0
  s_cbranch_scc1 Lopt_7
  s_add_u32 s28, s24, 0
  s_add_u32 m0, s25, 4096
  s_nop 0
  buffer_load_dwordx4 v2, s[12:15], s28 offen offset:0 nt lds
  buffer_load_dwordx4 v2, s[12:15], s28 offen offset:1024 nt lds
  buffer_load_dwordx4 v2, s[12:15], s28 offen offset:2048 nt lds
  buffer_load_dwordx4 v2, s[12:15], s28 offen offset:3072 nt lds
Lopt_7:
  s_add_u32 s28, s24, 4096
  s_add_u32 m0, s25, 12288
  s_nop 0
  buffer_load_dwordx4 v2, s[12:15], s28 offen offset:0 nt lds
  buffer_load_dwordx4 v2, s[12:15], s28 offen offset:1024 nt lds
  buffer_load_dwordx4 v2, s[12:15], s28 offen offset:2048 nt lds
  buffer_load_dwordx4 v2, s[12:15], s28 offen offset:3072 nt lds
  s_add_u32 s28, s24, 8192
  s_add_u32 m0, s25, 20480
  s_nop 0
  buffer_load_dwordx4 v2, s[12:15], s28 offen offset:0 nt lds
  buffer_load_dwordx4 v2, s[12:15], s28 offen offset:1024 nt lds
  buffer_load_dwordx4 v2, s[12:15], s28 offen offset:2048 nt lds
  buffer_load_dwordx4 v2, s[12:15], s28 offen offset:3072 nt lds
  s_mov_b32 s52, 0
  s_lshl_b32 s35, s52, 8
  s_add_u32 s35, s35, 155648
  s_lshl_b32 s52, s52, 13
  s_lshl_b32 s31, s32, 8
  s_add_u32 s31, s31, s52
  s_add_u32 s31, s31, 655360
  s_lshl_b32 s52, s3, 6
  s_add_u32 s52, s52, s31
  s_add_u32 s52, s4, s52
  s_addc_u32 s53, s5, 0
  s_mov_b32 s34, 0
Lqf_8:
  s_load_dwordx16 s[36:51], s[52:53], 0x0 glc
  s_add_u32 s34, s34, 1
  s_waitcnt lgkmcnt(0)
  s_cmp_ge_u32 s34, 20000
  s_cbranch_scc1 Lqo_9_t
  s_cmp_eq_u32 s36, -1
  s_cbranch_scc1 Lqf_8_s
  s_cmp_eq_u32 s51, -1
  s_cbranch_scc0 Lqo_9_t
Lqf_8_s:
  s_sleep 1
  s_branch Lqf_8
Lqo_9_t:
  v_writelane_b32 v11, s36, 0
  v_writelane_b32 v11, s37, 1
  v_writelane_b32 v11, s38, 2
  v_writelane_b32 v11, s39, 3
  v_writelane_b32 v11, s40, 4
  v_writelane_b32 v11, s41, 5
  v_writelane_b32 v11, s42, 6
  v_writelane_b32 v11, s43, 7
  v_writelane_b32 v11, s44, 8
  v_writelane_b32 v11, s45, 9
  v_writelane_b32 v11, s46, 10
  v_writelane_b32 v11, s47, 11
  v_writelane_b32 v11, s48, 12
  v_writelane_b32 v11, s49, 13
  v_writelane_b32 v11, s50, 14
  v_writelane_b32 v11, s51, 15
  s_cmp_ge_u32 s34, 20000
  s_cbranch_scc1 Lqo_9
  s_mov_b32 exec_lo, 0xffff
  s_mov_b32 exec_hi, 0
  v_cmp_eq_u32 vcc, -1, v11
  s_mov_b64 exec, -1
  s_nop 2
  s_cbranch_vccnz Lqf_8
Lqo_9:
  s_lshl_b32 s52, s3, 6
  s_add_u32 s52, s52, s35
  v_lshl_add_u32 v10, v0, 2, s52
  s_mov_b32 exec_lo, 0xffff
  s_mov_b32 exec_hi, 0
  ds_write_b32 v10, v11
  s_mov_b64 exec, -1
  s_waitcnt lgkmcnt(0)
  s_barrier
  v_bfe_u32 v56, v0, 3, 1
  v_lshlrev_b32 v56, 6, v56
  v_lshrrev_b32 v57, 4, v0
  v_lshl_add_u32 v56, v57, 4, v56
  v_add_u32 v56, s35, v56
  v_xor_b32 v57, 64, v56
  ds_read_b128 v[16:19], v56 offset:0
  ds_read_b128 v[20:23], v56 offset:128
  ds_read_b128 v[24:27], v57 offset:0
  ds_read_b128 v[28:31], v57 offset:128
  s_waitcnt lgkmcnt(0)
  s_waitcnt vmcnt(8)
  s_mov_b32 s26, 0
L_pass:
  v_mov_b32 v32, 0xff800000
  v_mov_b32 v33, 0xff800000
  v_mov_b32 v34, 0xff800000
  v_mov_b32 v35, 0xff800000
  v_mov_b32 v36, 0xff800000
  v_mov_b32 v37, 0xff800000
  v_mov_b32 v38, 0xff800000
  v_mov_b32 v39, 0xff800000
  v_mov_b32 v40, 0xff800000
  v_mov_b32 v41, 0xff800000
  v_mov_b32 v42, 0xff800000
  v_mov_b32 v43, 0xff800000
  s_cmp_eq_u32 s26, 2
  s_cbranch_scc0 Lstash_10
  s_lshl_b32 s52, s3, 10
  s_add_u32 s52, s52, 151552
  v_add_u32 v11, s52, v2
  ds_read_b128 v[36:39], v11
  s_waitcnt lgkmcnt(0)
Lstash_10:
  s_cmp_eq_u32 s27, 0
  s_cbranch_scc1 Lqk0_11
  ds_read_b128 v[56:59], v3 offset:0
  ds_read_b128 v[60:63], v3 offset:1024
  ds_read_b128 v[48:51], v3 offset:2048
  ds_read_b128 v[52:55], v3 offset:3072
  s_waitcnt lgkmcnt(2)
  v_mfma_f32_16x16x32_bf16 v[44:47], v[56:59], v[16:19], 0
  s_waitcnt lgkmcnt(0)
  v_mfma_f32_16x16x32_bf16 v[12:15], v[48:51], v[24:27], 0
  v_mfma_f32_16x16x32_bf16 v[44:47], v[60:63], v[20:23], v[44:47]
  v_mfma_f32_16x16x32_bf16 v[12:15], v[52:55], v[28:31], v[12:15]
  s_nop 6
  v_cndmask_b32 v32, v32, v44, s[56:57]
  v_cndmask_b32 v33, v33, v45, s[56:57]
  v_cndmask_b32 v34, v34, v46, s[56:57]
  v_cndmask_b32 v35, v35, v47, s[56:57]
  v_cndmask_b32 v32, v32, v12, s[58:59]
  v_cndmask_b32 v33, v33, v13, s[58:59]
  v_cndmask_b32 v34, v34, v14, s[58:59]
  v_cndmask_b32 v35, v35, v15, s[58:59]
Lqk0_11:
  ds_read_b128 v[56:59], v3 offset:8192
  ds_read_b128 v[60:63], v3 offset:9216
  v_mfma_f32_16x16x32_bf16 v[44:47], a[96:99], v[16:19], 0
  v_mfma_f32_16x16x32_bf16 v[44:47], a[100:103], v[20:23], v[44:47]
  v_mfma_f32_16x16x32_bf16 v[48:51], a[104:107], v[24:27], 0
  v_mfma_f32_16x16x32_bf16 v[48:51], a[108:111], v[28:31], v[48:51]
  s_cmp_eq_u32 s26, 1
  s_cbranch_scc0 Lqr_12
  s_add_u32 s28, s54, 45056
  buffer_load_dwordx4 a[96:99], v1, s[8:11], s28 offen offset:0 nt
  buffer_load_dwordx4 a[100:103], v1, s[8:11], s28 offen offset:128 nt
  buffer_load_dwordx4 a[104:107], v1, s[8:11], s28 offen offset:512 nt
  buffer_load_dwordx4 a[108:111], v1, s[8:11], s28 offen offset:640 nt
Lqr_12:
  v_mfma_f32_16x16x32_bf16 v[52:55], a[112:115], v[16:19], 0
  s_nop 2
  v_cndmask_b32 v32, v32, v44, s[68:69]
  v_cndmask_b32 v33, v33, v45, s[68:69]
  v_mfma_f32_16x16x32_bf16 v[52:55], a[116:119], v[20:23], v[52:55]
  v_cndmask_b32 v34, v34, v46, s[68:69]
  v_cndmask_b32 v35, v35, v47, s[68:69]
  v_mfma_f32_16x16x32_bf16 v[44:47], a[120:123], v[24:27], 0
  v_cndmask_b32 v32, v32, v48, s[70:71]
  v_cndmask_b32 v33, v33, v49, s[70:71]
  v_mfma_f32_16x16x32_bf16 v[44:47], a[124:127], v[28:31], v[44:47]
  v_cndmask_b32 v34, v34, v50, s[70:71]
  v_cndmask_b32 v35, v35, v51, s[70:71]
  s_cmp_eq_u32 s26, 1
  s_cbranch_scc0 Lqr_13
  s_add_u32 s28, s54, 49152
  buffer_load_dwordx4 a[112:115], v1, s[8:11], s28 offen offset:0 nt
  buffer_load_dwordx4 a[116:119], v1, s[8:11], s28 offen offset:128 nt
  buffer_load_dwordx4 a[120:123], v1, s[8:11], s28 offen offset:512 nt
  buffer_load_dwordx4 a[124:127], v1, s[8:11], s28 offen offset:640 nt
Lqr_13:
  s_waitcnt lgkmcnt(0)
  v_mfma_f32_16x16x32_bf16 v[48:51], v[56:59], v[16:19], 0
  v_cndmask_b32 v32, v32, v52, s[72:73]
  v_cndmask_b32 v33, v33, v53, s[72:73]
  v_mfma_f32_16x16x32_bf16 v[48:51], v[60:63], v[20:23], v[48:51]
  v_cndmask_b32 v34, v34, v54, s[72:73]
  v_cndmask_b32 v35, v35, v55, s[72:73]
  ds_read_b128 v[56:59], v3 offset:10240
  ds_read_b128 v[60:63], v3 offset:11264
  v_mfma_f32_16x16x32_bf16 v[52:55], a[128:131], v[16:19], 0
  v_cndmask_b32 v32, v32, v44, s[74:75]
  v_cndmask_b32 v33, v33, v45, s[74:75]
  v_mfma_f32_16x16x32_bf16 v[52:55], a[132:135], v[20:23], v[52:55]
  v_cndmask_b32 v34, v34, v46, s[74:75]
  v_cndmask_b32 v35, v35, v47, s[74:75]
  v_mfma_f32_16x16x32_bf16 v[44:47], a[136:139], v[24:27], 0
  v_cndmask_b32 v32, v32, v48, s[60:61]
  v_cndmask_b32 v33, v33, v49, s[60:61]
  v_mfma_f32_16x16x32_bf16 v[44:47], a[140:143], v[28:31], v[44:47]
  v_cndmask_b32 v34, v34, v50, s[60:61]
  v_cndmask_b32 v35, v35, v51, s[60:61]
  s_cmp_eq_u32 s26, 1
  s_cbranch_scc0 Lqr_14
  s_add_u32 s28, s54, 53248
  buffer_load_dwordx4 a[128:131], v1, s[8:11], s28 offen offset:0 nt
  buffer_load_dwordx4 a[132:135], v1, s[8:11], s28 offen offset:128 nt
  buffer_load_dwordx4 a[136:139], v1, s[8:11], s28 offen offset:512 nt
  buffer_load_dwordx4 a[140:143], v1, s[8:11], s28 offen offset:640 nt
Lqr_14:
  v_mfma_f32_16x16x32_bf16 v[48:51], a[144:147], v[16:19], 0
  v_cndmask_b32 v32, v32, v52, s[76:77]
  v_cndmask_b32 v33, v33, v53, s[76:77]
  v_mfma_f32_16x16x32_bf16 v[48:51], a[148:151], v[20:23], v[48:51]
  v_cndmask_b32 v34, v34, v54, s[76:77]
  v_cndmask_b32 v35, v35, v55, s[76:77]
  v_mfma_f32_16x16x32_bf16 v[52:55], a[152:155], v[24:27], 0
  v_cndmask_b32 v32, v32, v44, s[78:79]
  v_cndmask_b32 v33, v33, v45, s[78:79]
  v_mfma_f32_16x16x32_bf16 v[52:55], a[156:159], v[28:31], v[52:55]
  v_cndmask_b32 v34, v34, v46, s[78:79]
  v_cndmask_b32 v35, v35, v47, s[78:79]
  s_cmp_eq_u32 s26, 1
  s_cbranch_scc0 Lqr_15
  s_add_u32 s28, s54, 57344
  buffer_load_dwordx4 a[144:147], v1, s[8:11], s28 offen offset:0 nt
  buffer_load_dwordx4 a[148:151], v1, s[8:11], s28 offen offset:128 nt
  buffer_load_dwordx4 a[152:155], v1, s[8:11], s28 offen offset:512 nt
  buffer_load_dwordx4 a[156:159], v1, s[8:11], s28 offen offset:640 nt
Lqr_15:
  s_waitcnt lgkmcnt(0)
  v_mfma_f32_16x16x32_bf16 v[44:47], v[56:59], v[24:27], 0
  v_cndmask_b32 v32, v32, v48, s[80:81]
  v_cndmask_b32 v33, v33, v49, s[80:81]
  v_mfma_f32_16x16x32_bf16 v[44:47], v[60:63], v[28:31], v[44:47]
  v_cndmask_b32 v34, v34, v50, s[80:81]
  v_cndmask_b32 v35, v35, v51, s[80:81]
  s_cmp_eq_u32 s26, 1
  s_cbranch_scc0 Lqr_16
  s_add_u32 s28, s54, 4096
  s_add_u32 m0, s25, 8192
  s_add_u32 s51, s28, 0
  s_nop 0
  buffer_load_dwordx4 v1, s[8:11], s51 offen nt lds
  s_add_u32 m0, s25, 9216
  s_add_u32 s51, s28, 128
  s_nop 0
  buffer_load_dwordx4 v1, s[8:11], s51 offen nt lds
  s_add_u32 m0, s25, 10240
  s_add_u32 s51, s28, 512
  s_nop 0
  buffer_load_dwordx4 v1, s[8:11], s51 offen nt lds
  s_add_u32 m0, s25, 11264
  s_add_u32 s51, s28, 640
  s_nop 0
  buffer_load_dwordx4 v1, s[8:11], s51 offen nt lds
Lqr_16:
  ds_read_b128 v[56:59], v3 offset:16384
  ds_read_b128 v[60:63], v3 offset:17408
  v_mfma_f32_16x16x32_bf16 v[48:51], a[160:163], v[16:19], 0
  v_cndmask_b32 v32, v32, v52, s[82:83]
  v_cndmask_b32 v33, v33, v53, s[82:83]
  v_mfma_f32_16x16x32_bf16 v[48:51], a[164:167], v[20:23], v[48:51]
  v_cndmask_b32 v34, v34, v54, s[82:83]
  v_cndmask_b32 v35, v35, v55, s[82:83]
  v_mfma_f32_16x16x32_bf16 v[52:55], a[168:171], v[24:27], 0
  v_cndmask_b32 v32, v32, v44, s[62:63]
  v_cndmask_b32 v33, v33, v45, s[62:63]
  v_mfma_f32_16x16x32_bf16 v[52:55], a[172:175], v[28:31], v[52:55]
  v_cndmask_b32 v34, v34, v46, s[62:63]
  v_cndmask_b32 v35, v35, v47, s[62:63]
  v_mfma_f32_16x16x32_bf16 v[44:47], a[176:179], v[16:19], 0
  v_cndmask_b32 v32, v32, v48, s[84:85]
  v_cndmask_b32 v33, v33, v49, s[84:85]
  v_mfma_f32_16x16x32_bf16 v[44:47], a[180:183], v[20:23], v[44:47]
  v_cndmask_b32 v34, v34, v50, s[84:85]
  v_cndmask_b32 v35, v35, v51, s[84:85]
  v_mfma_f32_16x16x32_bf16 v[48:51], a[184:187], v[24:27], 0
  v_cndmask_b32 v32, v32, v52, s[86:87]
  v_cndmask_b32 v33, v33, v53, s[86:87]
  v_mfma_f32_16x16x32_bf16 v[48:51], a[188:191], v[28:31], v[48:51]
  v_cndmask_b32 v34, v34, v54, s[86:87]
  v_cndmask_b32 v35, v35, v55, s[86:87]
  s_waitcnt lgkmcnt(0)
  v_mfma_f32_16x16x32_bf16 v[52:55], v[56:59], v[16:19], 0
  v_cndmask_b32 v40, v40, v44, s[56:57]
  v_cndmask_b32 v41, v41, v45, s[56:57]
  v_mfma_f32_16x16x32_bf16 v[52:55], v[60:63], v[20:23], v[52:55]
  v_cndmask_b32 v42, v42, v46, s[56:57]
  v_cndmask_b32 v43, v43, v47, s[56:57]
  ds_read_b128 v[56:59], v3 offset:18432
  ds_read_b128 v[60:63], v3 offset:19456
  v_mfma_f32_16x16x32_bf16 v[44:47], a[192:195], v[16:19], 0
  v_cndmask_b32 v40, v40, v48, s[58:59]
  v_cndmask_b32 v41, v41, v49, s[58:59]
  v_mfma_f32_16x16x32_bf16 v[44:47], a[196:199], v[20:23], v[44:47]
  v_cndmask_b32 v42, v42, v50, s[58:59]
  v_cndmask_b32 v43, v43, v51, s[58:59]
  v_mfma_f32_16x16x32_bf16 v[48:51], a[200:203], v[24:27], 0
  v_cndmask_b32 v32, v32, v52, s[64:65]
  v_cndmask_b32 v33, v33, v53, s[64:65]
  v_mfma_f32_16x16x32_bf16 v[48:51], a[204:207], v[28:31], v[48:51]
  v_cndmask_b32 v34, v34, v54, s[64:65]
  v_cndmask_b32 v35, v35, v55, s[64:65]
  v_mfma_f32_16x16x32_bf16 v[52:55], a[208:211], v[16:19], 0
  v_cndmask_b32 v40, v40, v44, s[60:61]
  v_cndmask_b32 v41, v41, v45, s[60:61]
  v_mfma_f32_16x16x32_bf16 v[52:55], a[212:215], v[20:23], v[52:55]
  v_cndmask_b32 v42, v42, v46, s[60:61]
  v_cndmask_b32 v43, v43, v47, s[60:61]
  v_mfma_f32_16x16x32_bf16 v[44:47], a[216:219], v[24:27], 0
  v_cndmask_b32 v40, v40, v48, s[62:63]
  v_cndmask_b32 v41, v41, v49, s[62:63]
  v_mfma_f32_16x16x32_bf16 v[44:47], a[220:223], v[28:31], v[44:47]
  v_cndmask_b32 v42, v42, v50, s[62:63]
  v_cndmask_b32 v43, v43, v51, s[62:63]
  s_waitcnt lgkmcnt(0)
  v_mfma_f32_16x16x32_bf16 v[48:51], v[56:59], v[24:27], 0
  v_cndmask_b32 v40, v40, v52, s[64:65]
  v_cndmask_b32 v41, v41, v53, s[64:65]
  v_mfma_f32_16x16x32_bf16 v[48:51], v[60:63], v[28:31], v[48:51]
  v_cndmask_b32 v42, v42, v54, s[64:65]
  v_cndmask_b32 v43, v43, v55, s[64:65]
  v_cndmask_b32 v40, v40, v44, s[66:67]
  v_cndmask_b32 v41, v41, v45, s[66:67]
  v_cndmask_b32 v42, v42, v46, s[66:67]
  v_cndmask_b32 v43, v43, v47, s[66:67]
  s_nop 1
  v_cndmask_b32 v32, v32, v48, s[66:67]
  v_cndmask_b32 v33, v33, v49, s[66:67]
  v_cndmask_b32 v34, v34, v50, s[66:67]
  v_cndmask_b32 v35, v35, v51, s[66:67]
  s_cmp_eq_u32 s26, 2
  s_cbranch_scc1 Lqkb_17
  s_cmp_eq_u32 s26, 3
  s_cbranch_scc0 Lnw_18
  s_waitcnt vmcnt(0)
Lnw_18:
  ds_read_b128 v[56:59], v3 offset:24576
  ds_read_b128 v[60:63], v3 offset:25600
  v_mfma_f32_16x16x32_bf16 v[44:47], a[0:3], v[16:19], 0
  v_mfma_f32_16x16x32_bf16 v[44:47], a[4:7], v[20:23], v[44:47]
  v_mfma_f32_16x16x32_bf16 v[48:51], a[8:11], v[24:27], 0
  v_mfma_f32_16x16x32_bf16 v[48:51], a[12:15], v[28:31], v[48:51]
  v_mfma_f32_16x16x32_bf16 v[52:55], a[16:19], v[16:19], 0
  s_nop 4
  v_cndmask_b32 v36, v36, v44, s[64:65]
  v_cndmask_b32 v37, v37, v45, s[64:65]
  v_mfma_f32_16x16x32_bf16 v[52:55], a[20:23], v[20:23], v[52:55]
  v_cndmask_b32 v38, v38, v46, s[64:65]
  v_cndmask_b32 v39, v39, v47, s[64:65]
  s_waitcnt lgkmcnt(0)
  v_mfma_f32_16x16x32_bf16 v[44:47], v[56:59], v[16:19], 0
  v_cndmask_b32 v36, v36, v48, s[66:67]
  v_cndmask_b32 v37, v37, v49, s[66:67]
  v_mfma_f32_16x16x32_bf16 v[44:47], v[60:63], v[20:23], v[44:47]
  v_cndmask_b32 v38, v38, v50, s[66:67]
  v_cndmask_b32 v39, v39, v51, s[66:67]
  ds_read_b128 v[56:59], v3 offset:26624
  ds_read_b128 v[60:63], v3 offset:27648
  v_mfma_f32_16x16x32_bf16 v[48:51], a[24:27], v[24:27], 0
  v_cndmask_b32 v36, v36, v52, s[68:69]
  v_cndmask_b32 v37, v37, v53, s[68:69]
  v_mfma_f32_16x16x32_bf16 v[48:51], a[28:31], v[28:31], v[48:51]
  v_cndmask_b32 v38, v38, v54, s[68:69]
  v_cndmask_b32 v39, v39, v55, s[68:69]
  v_mfma_f32_16x16x32_bf16 v[52:55], a[32:35], v[16:19], 0
  v_cndmask_b32 v36, v36, v44, s[56:57]
  v_cndmask_b32 v37, v37, v45, s[56:57]
  v_mfma_f32_16x16x32_bf16 v[52:55], a[36:39], v[20:23], v[52:55]
  v_cndmask_b32 v38, v38, v46, s[56:57]
  v_cndmask_b32 v39, v39, v47, s[56:57]
  v_mfma_f32_16x16x32_bf16 v[44:47], a[40:43], v[24:27], 0
  v_cndmask_b32 v36, v36, v48, s[70:71]
  v_cndmask_b32 v37, v37, v49, s[70:71]
  v_mfma_f32_16x16x32_bf16 v[44:47], a[44:47], v[28:31], v[44:47]
  v_cndmask_b32 v38, v38, v50, s[70:71]
  v_cndmask_b32 v39, v39, v51, s[70:71]
  s_waitcnt lgkmcnt(0)
  v_mfma_f32_16x16x32_bf16 v[48:51], v[56:59], v[24:27], 0
  v_cndmask_b32 v36, v36, v52, s[72:73]
  v_cndmask_b32 v37, v37, v53, s[72:73]
  v_mfma_f32_16x16x32_bf16 v[48:51], v[60:63], v[28:31], v[48:51]
  v_cndmask_b32 v38, v38, v54, s[72:73]
  v_cndmask_b32 v39, v39, v55, s[72:73]
  ds_read_b128 v[56:59], v3 offset:32768
  ds_read_b128 v[60:63], v3 offset:33792
  v_mfma_f32_16x16x32_bf16 v[52:55], a[48:51], v[16:19], 0
  v_cndmask_b32 v36, v36, v44, s[74:75]
  v_cndmask_b32 v37, v37, v45, s[74:75]
  v_mfma_f32_16x16x32_bf16 v[52:55], a[52:55], v[20:23], v[52:55]
  v_cndmask_b32 v38, v38, v46, s[74:75]
  v_cndmask_b32 v39, v39, v47, s[74:75]
  v_mfma_f32_16x16x32_bf16 v[44:47], a[56:59], v[24:27], 0
  v_cndmask_b32 v36, v36, v48, s[58:59]
  v_cndmask_b32 v37, v37, v49, s[58:59]
  v_mfma_f32_16x16x32_bf16 v[44:47], a[60:63], v[28:31], v[44:47]
  v_cndmask_b32 v38, v38, v50, s[58:59]
  v_cndmask_b32 v39, v39, v51, s[58:59]
  v_mfma_f32_16x16x32_bf16 v[48:51], a[64:67], v[16:19], 0
  v_cndmask_b32 v36, v36, v52, s[76:77]
  v_cndmask_b32 v37, v37, v53, s[76:77]
  v_mfma_f32_16x16x32_bf16 v[48:51], a[68:71], v[20:23], v[48:51]
  v_cndmask_b32 v38, v38, v54, s[76:77]
  v_cndmask_b32 v39, v39, v55, s[76:77]
  s_waitcnt lgkmcnt(0)
  v_mfma_f32_16x16x32_bf16 v[52:55], v[56:59], v[16:19], 0
  v_cndmask_b32 v36, v36, v44, s[78:79]
  v_cndmask_b32 v37, v37, v45, s[78:79]
  v_mfma_f32_16x16x32_bf16 v[52:55], v[60:63], v[20:23], v[52:55]
  v_cndmask_b32 v38, v38, v46, s[78:79]
  v_cndmask_b32 v39, v39, v47, s[78:79]
  ds_read_b128 v[56:59], v3 offset:34816
  ds_read_b128 v[60:63], v3 offset:35840
  v_mfma_f32_16x16x32_bf16 v[44:47], a[72:75], v[24:27], 0
  v_cndmask_b32 v36, v36, v48, s[80:81]
  v_cndmask_b32 v37, v37, v49, s[80:81]
  v_mfma_f32_16x16x32_bf16 v[44:47], a[76:79], v[28:31], v[44:47]
  v_cndmask_b32 v38, v38, v50, s[80:81]
  v_cndmask_b32 v39, v39, v51, s[80:81]
  v_mfma_f32_16x16x32_bf16 v[48:51], a[80:83], v[16:19], 0
  v_cndmask_b32 v36, v36, v52, s[60:61]
  v_cndmask_b32 v37, v37, v53, s[60:61]
  v_mfma_f32_16x16x32_bf16 v[48:51], a[84:87], v[20:23], v[48:51]
  v_cndmask_b32 v38, v38, v54, s[60:61]
  v_cndmask_b32 v39, v39, v55, s[60:61]
  v_mfma_f32_16x16x32_bf16 v[52:55], a[88:91], v[24:27], 0
  v_cndmask_b32 v36, v36, v44, s[82:83]
  v_cndmask_b32 v37, v37, v45, s[82:83]
  v_mfma_f32_16x16x32_bf16 v[52:55], a[92:95], v[28:31], v[52:55]
  v_cndmask_b32 v38, v38, v46, s[82:83]
  v_cndmask_b32 v39, v39, v47, s[82:83]
  s_waitcnt lgkmcnt(0)
  v_mfma_f32_16x16x32_bf16 v[44:47], v[56:59], v[24:27], 0
  v_cndmask_b32 v36, v36, v48, s[84:85]
  v_cndmask_b32 v37, v37, v49, s[84:85]
  v_mfma_f32_16x16x32_bf16 v[44:47], v[60:63], v[28:31], v[44:47]
  v_cndmask_b32 v38, v38, v50, s[84:85]
  v_cndmask_b32 v39, v39, v51, s[84:85]
  v_cndmask_b32 v36, v36, v52, s[86:87]
  v_cndmask_b32 v37, v37, v53, s[86:87]
  v_cndmask_b32 v38, v38, v54, s[86:87]
  v_cndmask_b32 v39, v39, v55, s[86:87]
  s_nop 1
  v_cndmask_b32 v36, v36, v44, s[62:63]
  v_cndmask_b32 v37, v37, v45, s[62:63]
  v_cndmask_b32 v38, v38, v46, s[62:63]
  v_cndmask_b32 v39, v39, v47, s[62:63]
Lqkb_17:
  s_cmp_eq_u32 s26, 1
  s_cbranch_scc0 Lrl1_20
  s_add_u32 s24, s24, 0x4000000
  s_cmp_eq_u32 s27, 0
  s_cbranch_scc1 Lopt_21
  s_add_u32 s28, s24, 0
  s_add_u32 m0, s25, 0
  s_add_u32 s51, s28, 0
  buffer_load_dwordx4 v1, s[8:11], s51 offen nt lds
  s_add_u32 m0, s25, 1024
  s_add_u32 s51, s28, 128
  buffer_load_dwordx4 v1, s[8:11], s51 offen nt lds
  s_add_u32 m0, s25, 2048
  s_add_u32 s51, s28, 512
  buffer_load_dwordx4 v1, s[8:11], s51 offen nt lds
  s_add_u32 m0, s25, 3072
  s_add_u32 s51, s28, 640
  buffer_load_dwordx4 v1, s[8:11], s51 offen nt lds
Lopt_21:
  s_add_u32 s28, s24, 8192
  s_add_u32 m0, s25, 16384
  s_add_u32 s51, s28, 0
  buffer_load_dwordx4 v1, s[8:11], s51 offen nt lds
  s_add_u32 m0, s25, 17408
  s_add_u32 s51, s28, 128
  buffer_load_dwordx4 v1, s[8:11], s51 offen nt lds
  s_add_u32 m0, s25, 18432
  s_add_u32 s51, s28, 512
  buffer_load_dwordx4 v1, s[8:11], s51 offen nt lds
  s_add_u32 m0, s25, 19456
  s_add_u32 s51, s28, 640
  buffer_load_dwordx4 v1, s[8:11], s51 offen nt lds
Lrl1_20:
  v_mov_b32_dpp v44, v32 row_ror:8 row_mask:0xf bank_mask:0xf
  v_mov_b32_dpp v45, v33 row_ror:8 row_mask:0xf bank_mask:0xf
  v_mov_b32_dpp v46, v34 row_ror:8 row_mask:0xf bank_mask:0xf
  v_mov_b32_dpp v47, v35 row_ror:8 row_mask:0xf bank_mask:0xf
  v_mov_b32_dpp v48, v36 row_ror:8 row_mask:0xf bank_mask:0xf
  v_mov_b32_dpp v49, v37 row_ror:8 row_mask:0xf bank_mask:0xf
  v_mov_b32_dpp v50, v38 row_ror:8 row_mask:0xf bank_mask:0xf
  v_mov_b32_dpp v51, v39 row_ror:8 row_mask:0xf bank_mask:0xf
  v_mov_b32_dpp v52, v40 row_ror:8 row_mask:0xf bank_mask:0xf
  v_mov_b32_dpp v53, v41 row_ror:8 row_mask:0xf bank_mask:0xf
  v_mov_b32_dpp v54, v42 row_ror:8 row_mask:0xf bank_mask:0xf
  v_mov_b32_dpp v55, v43 row_ror:8 row_mask:0xf bank_mask:0xf
  v_permlane32_swap_b32 v32, v44
  v_permlane32_swap_b32 v33, v45
  v_permlane32_swap_b32 v34, v46
  v_permlane32_swap_b32 v35, v47
  v_permlane32_swap_b32 v36, v48
  v_permlane32_swap_b32 v37, v49
  v_permlane32_swap_b32 v38, v50
  v_permlane32_swap_b32 v39, v51
  v_permlane32_swap_b32 v40, v52
  v_permlane32_swap_b32 v41, v53
  v_permlane32_swap_b32 v42, v54
  v_permlane32_swap_b32 v43, v55
  v_add_f32_dpp v32, v44, v32 row_ror:8 row_mask:0xf bank_mask:0xf
  v_add_f32_dpp v33, v45, v33 row_ror:8 row_mask:0xf bank_mask:0xf
  v_add_f32_dpp v34, v46, v34 row_ror:8 row_mask:0xf bank_mask:0xf
  v_add_f32_dpp v35, v47, v35 row_ror:8 row_mask:0xf bank_mask:0xf
  v_add_f32_dpp v36, v48, v36 row_ror:8 row_mask:0xf bank_mask:0xf
  v_add_f32_dpp v37, v49, v37 row_ror:8 row_mask:0xf bank_mask:0xf
  v_add_f32_dpp v38, v50, v38 row_ror:8 row_mask:0xf bank_mask:0xf
  v_add_f32_dpp v39, v51, v39 row_ror:8 row_mask:0xf bank_mask:0xf
  v_add_f32_dpp v40, v52, v40 row_ror:8 row_mask:0xf bank_mask:0xf
  v_add_f32_dpp v41, v53, v41 row_ror:8 row_mask:0xf bank_mask:0xf
  v_add_f32_dpp v42, v54, v42 row_ror:8 row_mask:0xf bank_mask:0xf
  v_add_f32_dpp v43, v55, v43 row_ror:8 row_mask:0xf bank_mask:0xf
  v_max3_f32 v11, v32, v33, v34
  v_max3_f32 v11, v11, v35, v36
  v_max3_f32 v11, v11, v37, v38
  v_max3_f32 v11, v11, v39, v40
  v_max3_f32 v11, v11, v41, v42
  v_max_f32 v11, v11, v43
  s_nop 1
  v_max_f32_dpp v11, v11, v11 row_ror:8 row_mask:0xf bank_mask:0xf
  s_nop 1
  v_max_f32_dpp v11, v11, v11 row_ror:4 row_mask:0xf bank_mask:0xf
  s_nop 1
  v_max_f32_dpp v11, v11, v11 row_ror:2 row_mask:0xf bank_mask:0xf
  s_nop 1
  v_max_f32_dpp v11, v11, v11 row_ror:1 row_mask:0xf bank_mask:0xf
  s_nop 0
  v_readlane_b32 s50, v11, 0
  v_readlane_b32 s51, v11, 16
  v_readlane_b32 s52, v11, 32
  v_readlane_b32 s53, v11, 48
  v_mov_b32 v11, s50
  v_max_f32 v11, s51, v11
  v_max_f32 v11, s52, v11
  v_max_f32 v11, s53, v11
  v_mul_f32 v11, s55, v11
  v_fma_f32 v32, v32, s55, -v11
  v_fma_f32 v33, v33, s55, -v11
  v_fma_f32 v34, v34, s55, -v11
  v_fma_f32 v35, v35, s55, -v11
  v_fma_f32 v36, v36, s55, -v11
  v_fma_f32 v37, v37, s55, -v11
  v_fma_f32 v38, v38, s55, -v11
  v_fma_f32 v39, v39, s55, -v11
  v_fma_f32 v40, v40, s55, -v11
  v_fma_f32 v41, v41, s55, -v11
  v_fma_f32 v42, v42, s55, -v11
  v_fma_f32 v43, v43, s55, -v11
  v_exp_f32 v32, v32
  v_exp_f32 v33, v33
  v_exp_f32 v34, v34
  v_exp_f32 v35, v35
  v_exp_f32 v36, v36
  v_exp_f32 v37, v37
  v_exp_f32 v38, v38
  v_exp_f32 v39, v39
  v_exp_f32 v40, v40
  v_exp_f32 v41, v41
  v_exp_f32 v42, v42
  v_exp_f32 v43, v43
  v_add_f32 v10, v32, v33
  v_add_f32 v10, v10, v34
  v_add_f32 v10, v10, v35
  v_add_f32 v10, v10, v36
  v_add_f32 v10, v10, v37
  v_add_f32 v10, v10, v38
  v_add_f32 v10, v10, v39
  v_add_f32 v10, v10, v40
  v_add_f32 v10, v10, v41
  v_add_f32 v10, v10, v42
  v_add_f32 v10, v10, v43
  v_cvt_pk_bf16_f32 v32, v32, 0
  v_cvt_pk_bf16_f32 v33, v33, 0
  v_cvt_pk_bf16_f32 v34, v34, 0
  v_cvt_pk_bf16_f32 v35, v35, 0
  v_cvt_pk_bf16_f32 v36, v36, 0
  v_cvt_pk_bf16_f32 v37, v37, 0
  v_cvt_pk_bf16_f32 v38, v38, 0
  v_cvt_pk_bf16_f32 v39, v39, 0
  v_cvt_pk_bf16_f32 v40, v40, 0
  v_cvt_pk_bf16_f32 v41, v41, 0
  v_cvt_pk_bf16_f32 v42, v42, 0
  v_cvt_pk_bf16_f32 v43, v43, 0
  v_mov_b32 v12, 0
  v_mov_b32 v13, 0
  v_mov_b32 v14, 0
  v_mov_b32 v15, 0
  v_add_f32_dpp v10, v10, v10 row_ror:8 row_mask:0xf bank_mask:0xf
  s_nop 1
  v_add_f32_dpp v10, v10, v10 row_ror:4 row_mask:0xf bank_mask:0xf
  s_nop 1
  v_add_f32_dpp v10, v10, v10 row_ror:2 row_mask:0xf bank_mask:0xf
  s_nop 1
  v_add_f32_dpp v10, v10, v10 row_ror:1 row_mask:0xf bank_mask:0xf
  s_nop 0
  v_readlane_b32 s50, v10, 0
  v_readlane_b32 s51, v10, 16
  v_readlane_b32 s52, v10, 32
  v_readlane_b32 s53, v10, 48
  v_mov_b32 v10, s50
  v_add_f32 v10, s51, v10
  v_add_f32 v10, s52, v10
  v_add_f32 v10, s53, v10
  v_mov_b32 v56, v11
  v_mul_f32 v57, 0.5, v10
  s_lshl_b32 s52, s3, 3
  s_add_u32 s52, s52, 147456
  v_mov_b32 v58, s52
  ds_write_b64 v58, v[56:57]
  s_bitcmp1_b32 s26, 0
  s_cbranch_scc1 Lpvres_22
  s_cmp_eq_u32 s27, 0
  s_cbranch_scc1 Lpa0_24
  s_waitcnt vmcnt(8)
  ds_read_b128 v[56:59], v3 offset:4096
  ds_read_b128 v[60:63], v3 offset:5120
  ds_read_b128 v[52:55], v3 offset:6144
  v_mov_b32_dpp v6, v32 row_newbcast:0 row_mask:0xf bank_mask:0xf
  v_mov_b32_dpp v8, v33 row_newbcast:0 row_mask:0xf bank_mask:0xf
  v_lshlrev_b64 v[44:45], v4, v[6:7]
  v_lshlrev_b64 v[46:47], v5, v[6:7]
  v_mov_b32_dpp v6, v34 row_newbcast:0 row_mask:0xf bank_mask:0xf
  v_lshlrev_b64 v[48:49], v4, v[8:9]
  v_lshlrev_b64 v[50:51], v5, v[8:9]
  s_waitcnt lgkmcnt(0)
  v_mfma_f32_16x16x32_bf16 v[12:15], v[44:47], v[56:59], v[12:15]
  v_lshlrev_b64 v[44:45], v4, v[6:7]
  v_lshlrev_b64 v[46:47], v5, v[6:7]
  s_waitcnt lgkmcnt(0)
  v_mfma_f32_16x16x32_bf16 v[12:15], v[48:51], v[60:63], v[12:15]
  s_waitcnt lgkmcnt(0)
  v_mfma_f32_16x16x32_bf16 v[12:15], v[44:47], v[52:55], v[12:15]
  ds_read_b128 v[56:59], v3 offset:7168
  v_mov_b32_dpp v8, v35 row_newbcast:0 row_mask:0xf bank_mask:0xf
  v_lshlrev_b64 v[48:49], v4, v[8:9]
  v_lshlrev_b64 v[50:51], v5, v[8:9]
  s_waitcnt lgkmcnt(0)
  s_nop 0
  v_mfma_f32_16x16x32_bf16 v[12:15], v[48:51], v[56:59], v[12:15]
Lpa0_24:
  s_add_u32 s28, s24, 12288
  s_add_u32 m0, s25, 28672
  s_nop 0
  buffer_load_dwordx4 v2, s[12:15], s28 offen offset:0 nt lds
  buffer_load_dwordx4 v2, s[12:15], s28 offen offset:1024 nt lds
  buffer_load_dwordx4 v2, s[12:15], s28 offen offset:2048 nt lds
  buffer_load_dwordx4 v2, s[12:15], s28 offen offset:3072 nt lds
  s_waitcnt vmcnt(8)
  ds_read_b128 v[56:59], v3 offset:12288
  ds_read_b128 v[60:63], v3 offset:13312
  ds_read_b128 v[52:55], v3 offset:14336
  v_mov_b32_dpp v6, v32 row_newbcast:1 row_mask:0xf bank_mask:0xf
  v_mov_b32_dpp v8, v33 row_newbcast:1 row_mask:0xf bank_mask:0xf
  v_lshlrev_b64 v[44:45], v4, v[6:7]
  v_lshlrev_b64 v[46:47], v5, v[6:7]
  v_mov_b32_dpp v6, v34 row_newbcast:1 row_mask:0xf bank_mask:0xf
  v_lshlrev_b64 v[48:49], v4, v[8:9]
  v_lshlrev_b64 v[50:51], v5, v[8:9]
  s_waitcnt lgkmcnt(0)
  v_mfma_f32_16x16x32_bf16 v[12:15], v[44:47], v[56:59], v[12:15]
  v_lshlrev_b64 v[44:45], v4, v[6:7]
  v_lshlrev_b64 v[46:47], v5, v[6:7]
  s_waitcnt lgkmcnt(0)
  v_mfma_f32_16x16x32_bf16 v[12:15], v[48:51], v[60:63], v[12:15]
  s_waitcnt lgkmcnt(0)
  v_mfma_f32_16x16x32_bf16 v[12:15], v[44:47], v[52:55], v[12:15]
  ds_read_b128 v[56:59], v3 offset:15360
  v_mov_b32_dpp v8, v35 row_newbcast:1 row_mask:0xf bank_mask:0xf
  v_lshlrev_b64 v[48:49], v4, v[8:9]
  v_lshlrev_b64 v[50:51], v5, v[8:9]
  s_waitcnt lgkmcnt(0)
  s_nop 0
  v_mfma_f32_16x16x32_bf16 v[12:15], v[48:51], v[56:59], v[12:15]
  s_add_u32 s28, s24, 16384
  s_add_u32 m0, s25, 36864
  s_nop 0
  buffer_load_dwordx4 v2, s[12:15], s28 offen offset:0 nt lds
  buffer_load_dwordx4 v2, s[12:15], s28 offen offset:1024 nt lds
  buffer_load_dwordx4 v2, s[12:15], s28 offen offset:2048 nt lds
  buffer_load_dwordx4 v2, s[12:15], s28 offen offset:3072 nt lds
  s_waitcnt vmcnt(8)
  ds_read_b128 v[56:59], v3 offset:20480
  ds_read_b128 v[60:63], v3 offset:21504
  ds_read_b128 v[52:55], v3 offset:22528
  v_mov_b32_dpp v6, v32 row_newbcast:2 row_mask:0xf bank_mask:0xf
  v_mov_b32_dpp v8, v33 row_newbcast:2 row_mask:0xf bank_mask:0xf
  v_lshlrev_b64 v[44:45], v4, v[6:7]
  v_lshlrev_b64 v[46:47], v5, v[6:7]
  v_mov_b32_dpp v6, v34 row_newbcast:2 row_mask:0xf bank_mask:0xf
  v_lshlrev_b64 v[48:49], v4, v[8:9]
  v_lshlrev_b64 v[50:51], v5, v[8:9]
  s_waitcnt lgkmcnt(0)
  v_mfma_f32_16x16x32_bf16 v[12:15], v[44:47], v[56:59], v[12:15]
  v_lshlrev_b64 v[44:45], v4, v[6:7]
  v_lshlrev_b64 v[46:47], v5, v[6:7]
  s_waitcnt lgkmcnt(0)
  v_mfma_f32_16x16x32_bf16 v[12:15], v[48:51], v[60:63], v[12:15]
  s_waitcnt lgkmcnt(0)
  v_mfma_f32_16x16x32_bf16 v[12:15], v[44:47], v[52:55], v[12:15]
  ds_read_b128 v[56:59], v3 offset:23552
  v_mov_b32_dpp v8, v35 row_newbcast:2 row_mask:0xf bank_mask:0xf
  v_lshlrev_b64 v[48:49], v4, v[8:9]
  v_lshlrev_b64 v[50:51], v5, v[8:9]
  s_waitcnt lgkmcnt(0)
  s_nop 0
  v_mfma_f32_16x16x32_bf16 v[12:15], v[48:51], v[56:59], v[12:15]
  s_add_u32 s28, s24, 20480
  buffer_load_dwordx4 a[224:227], v2, s[12:15], s28 offen offset:0 nt
  buffer_load_dwordx4 a[228:231], v2, s[12:15], s28 offen offset:1024 nt
  buffer_load_dwordx4 a[232:235], v2, s[12:15], s28 offen offset:2048 nt
  buffer_load_dwordx4 a[236:239], v2, s[12:15], s28 offen offset:3072 nt
  s_waitcnt vmcnt(8)
  ds_read_b128 v[56:59], v3 offset:28672
  ds_read_b128 v[60:63], v3 offset:29696
  ds_read_b128 v[52:55], v3 offset:30720
  v_mov_b32_dpp v6, v36 row_newbcast:0 row_mask:0xf bank_mask:0xf
  v_mov_b32_dpp v8, v37 row_newbcast:0 row_mask:0xf bank_mask:0xf
  v_lshlrev_b64 v[44:45], v4, v[6:7]
  v_lshlrev_b64 v[46:47], v5, v[6:7]
  v_mov_b32_dpp v6, v38 row_newbcast:0 row_mask:0xf bank_mask:0xf
  v_lshlrev_b64 v[48:49], v4, v[8:9]
  v_lshlrev_b64 v[50:51], v5, v[8:9]
  s_waitcnt lgkmcnt(0)
  v_mfma_f32_16x16x32_bf16 v[12:15], v[44:47], v[56:59], v[12:15]
  v_lshlrev_b64 v[44:45], v4, v[6:7]
  v_lshlrev_b64 v[46:47], v5, v[6:7]
  s_waitcnt lgkmcnt(0)
  v_mfma_f32_16x16x32_bf16 v[12:15], v[48:51], v[60:63], v[12:15]
  s_waitcnt lgkmcnt(0)
  v_mfma_f32_16x16x32_bf16 v[12:15], v[44:47], v[52:55], v[12:15]
  ds_read_b128 v[56:59], v3 offset:31744
  v_mov_b32_dpp v8, v39 row_newbcast:0 row_mask:0xf bank_mask:0xf
  v_lshlrev_b64 v[48:49], v4, v[8:9]
  v_lshlrev_b64 v[50:51], v5, v[8:9]
  s_waitcnt lgkmcnt(0)
  s_nop 0
  v_mfma_f32_16x16x32_bf16 v[12:15], v[48:51], v[56:59], v[12:15]
  s_add_u32 s28, s24, 24576
  buffer_load_dwordx4 a[240:243], v2, s[12:15], s28 offen offset:0 nt
  buffer_load_dwordx4 a[244:247], v2, s[12:15], s28 offen offset:1024 nt
  buffer_load_dwordx4 a[248:251], v2, s[12:15], s28 offen offset:2048 nt
  buffer_load_dwordx4 a[252:255], v2, s[12:15], s28 offen offset:3072 nt
  s_waitcnt vmcnt(8)
  ds_read_b128 v[56:59], v3 offset:36864
  ds_read_b128 v[60:63], v3 offset:37888
  ds_read_b128 v[52:55], v3 offset:38912
  v_mov_b32_dpp v6, v36 row_newbcast:1 row_mask:0xf bank_mask:0xf
  v_mov_b32_dpp v8, v37 row_newbcast:1 row_mask:0xf bank_mask:0xf
  v_lshlrev_b64 v[44:45], v4, v[6:7]
  v_lshlrev_b64 v[46:47], v5, v[6:7]
  v_mov_b32_dpp v6, v38 row_newbcast:1 row_mask:0xf bank_mask:0xf
  v_lshlrev_b64 v[48:49], v4, v[8:9]
  v_lshlrev_b64 v[50:51], v5, v[8:9]
  s_waitcnt lgkmcnt(0)
  v_mfma_f32_16x16x32_bf16 v[12:15], v[44:47], v[56:59], v[12:15]
  v_lshlrev_b64 v[44:45], v4, v[6:7]
  v_lshlrev_b64 v[46:47], v5, v[6:7]
  s_waitcnt lgkmcnt(0)
  v_mfma_f32_16x16x32_bf16 v[12:15], v[48:51], v[60:63], v[12:15]
  s_waitcnt lgkmcnt(0)
  v_mfma_f32_16x16x32_bf16 v[12:15], v[44:47], v[52:55], v[12:15]
  ds_read_b128 v[56:59], v3 offset:39936
  v_mov_b32_dpp v8, v39 row_newbcast:1 row_mask:0xf bank_mask:0xf
  v_lshlrev_b64 v[48:49], v4, v[8:9]
  v_lshlrev_b64 v[50:51], v5, v[8:9]
  s_waitcnt lgkmcnt(0)
  s_nop 0
  v_mfma_f32_16x16x32_bf16 v[12:15], v[48:51], v[56:59], v[12:15]
  s_add_u32 s28, s24, 28672
  buffer_load_dwordx4 v[64:67], v2, s[12:15], s28 offen offset:0 nt
  buffer_load_dwordx4 v[68:71], v2, s[12:15], s28 offen offset:1024 nt
  buffer_load_dwordx4 v[72:75], v2, s[12:15], s28 offen offset:2048 nt
  buffer_load_dwordx4 v[76:79], v2, s[12:15], s28 offen offset:3072 nt
  s_waitcnt vmcnt(8)
  v_mov_b32_dpp v6, v36 row_newbcast:2 row_mask:0xf bank_mask:0xf
  v_mov_b32_dpp v8, v37 row_newbcast:2 row_mask:0xf bank_mask:0xf
  v_lshlrev_b64 v[44:45], v4, v[6:7]
  v_lshlrev_b64 v[46:47], v5, v[6:7]
  v_mov_b32_dpp v6, v38 row_newbcast:2 row_mask:0xf bank_mask:0xf
  v_lshlrev_b64 v[48:49], v4, v[8:9]
  v_lshlrev_b64 v[50:51], v5, v[8:9]
  v_mfma_f32_16x16x32_bf16 v[12:15], v[44:47], a[224:227], v[12:15]
  v_mov_b32_dpp v8, v39 row_newbcast:2 row_mask:0xf bank_mask:0xf
  v_lshlrev_b64 v[44:45], v4, v[6:7]
  v_lshlrev_b64 v[46:47], v5, v[6:7]
  v_mfma_f32_16x16x32_bf16 v[12:15], v[48:51], a[228:231], v[12:15]
  s_add_u32 s28, s24, 32768
  buffer_load_dwordx4 v[80:83], v2, s[12:15], s28 offen offset:0 nt
  buffer_load_dwordx4 v[84:87], v2, s[12:15], s28 offen offset:1024 nt
  buffer_load_dwordx4 v[88:91], v2, s[12:15], s28 offen offset:2048 nt
  buffer_load_dwordx4 v[92:95], v2, s[12:15], s28 offen offset:3072 nt
  s_waitcnt vmcnt(8)
  v_mov_b32_dpp v6, v36 row_newbcast:3 row_mask:0xf bank_mask:0xf
  v_lshlrev_b64 v[48:49], v4, v[8:9]
  v_lshlrev_b64 v[50:51], v5, v[8:9]
  v_mfma_f32_16x16x32_bf16 v[12:15], v[44:47], a[232:235], v[12:15]
  v_mov_b32_dpp v8, v37 row_newbcast:3 row_mask:0xf bank_mask:0xf
  v_lshlrev_b64 v[44:45], v4, v[6:7]
  v_lshlrev_b64 v[46:47], v5, v[6:7]
  v_mfma_f32_16x16x32_bf16 v[12:15], v[48:51], a[236:239], v[12:15]
  v_mov_b32_dpp v6, v38 row_newbcast:3 row_mask:0xf bank_mask:0xf
  v_lshlrev_b64 v[48:49], v4, v[8:9]
  v_lshlrev_b64 v[50:51], v5, v[8:9]
  v_mfma_f32_16x16x32_bf16 v[12:15], v[44:47], a[240:243], v[12:15]
  v_mov_b32_dpp v8, v39 row_newbcast:3 row_mask:0xf bank_mask:0xf
  v_lshlrev_b64 v[44:45], v4, v[6:7]
  v_lshlrev_b64 v[46:47], v5, v[6:7]
  v_mfma_f32_16x16x32_bf16 v[12:15], v[48:51], a[244:247], v[12:15]
  s_add_u32 s28, s24, 36864
  buffer_load_dwordx4 v[96:99], v2, s[12:15], s28 offen offset:0 nt
  buffer_load_dwordx4 v[100:103], v2, s[12:15], s28 offen offset:1024 nt
  buffer_load_dwordx4 v[104:107], v2, s[12:15], s28 offen offset:2048 nt
  buffer_load_dwordx4 v[108:111], v2, s[12:15], s28 offen offset:3072 nt
  s_waitcnt vmcnt(8)
  v_mov_b32_dpp v6, v36 row_newbcast:4 row_mask:0xf bank_mask:0xf
  v_lshlrev_b64 v[48:49], v4, v[8:9]
  v_lshlrev_b64 v[50:51], v5, v[8:9]
  v_mfma_f32_16x16x32_bf16 v[12:15], v[44:47], a[248:251], v[12:15]
  v_mov_b32_dpp v8, v37 row_newbcast:4 row_mask:0xf bank_mask:0xf
  v_lshlrev_b64 v[44:45], v4, v[6:7]
  v_lshlrev_b64 v[46:47], v5, v[6:7]
  v_mfma_f32_16x16x32_bf16 v[12:15], v[48:51], a[252:255], v[12:15]
  v_mov_b32_dpp v6, v38 row_newbcast:4 row_mask:0xf bank_mask:0xf
  v_lshlrev_b64 v[48:49], v4, v[8:9]
  v_lshlrev_b64 v[50:51], v5, v[8:9]
  v_mfma_f32_16x16x32_bf16 v[12:15], v[44:47], v[64:67], v[12:15]
  v_mov_b32_dpp v8, v39 row_newbcast:4 row_mask:0xf bank_mask:0xf
  v_lshlrev_b64 v[44:45], v4, v[6:7]
  v_lshlrev_b64 v[46:47], v5, v[6:7]
  v_mfma_f32_16x16x32_bf16 v[12:15], v[48:51], v[68:71], v[12:15]
  s_add_u32 s28, s24, 40960
  buffer_load_dwordx4 v[112:115], v2, s[12:15], s28 offen offset:0 nt
  buffer_load_dwordx4 v[116:119], v2, s[12:15], s28 offen offset:1024 nt
  buffer_load_dwordx4 v[120:123], v2, s[12:15], s28 offen offset:2048 nt
  buffer_load_dwordx4 v[124:127], v2, s[12:15], s28 offen offset:3072 nt
  s_waitcnt vmcnt(8)
  v_mov_b32_dpp v6, v36 row_newbcast:5 row_mask:0xf bank_mask:0xf
  v_lshlrev_b64 v[48:49], v4, v[8:9]
  v_lshlrev_b64 v[50:51], v5, v[8:9]
  v_mfma_f32_16x16x32_bf16 v[12:15], v[44:47], v[72:75], v[12:15]
  v_mov_b32_dpp v8, v37 row_newbcast:5 row_mask:0xf bank_mask:0xf
  v_lshlrev_b64 v[44:45], v4, v[6:7]
  v_lshlrev_b64 v[46:47], v5, v[6:7]
  v_mfma_f32_16x16x32_bf16 v[12:15], v[48:51], v[76:79], v[12:15]
  v_mov_b32_dpp v6, v38 row_newbcast:5 row_mask:0xf bank_mask:0xf
  v_lshlrev_b64 v[48:49], v4, v[8:9]
  v_lshlrev_b64 v[50:51], v5, v[8:9]
  v_mfma_f32_16x16x32_bf16 v[12:15], v[44:47], v[80:83], v[12:15]
  v_mov_b32_dpp v8, v39 row_newbcast:5 row_mask:0xf bank_mask:0xf
  v_lshlrev_b64 v[44:45], v4, v[6:7]
  v_lshlrev_b64 v[46:47], v5, v[6:7]
  v_mfma_f32_16x16x32_bf16 v[12:15], v[48:51], v[84:87], v[12:15]
  s_add_u32 s28, s24, 45056
  buffer_load_dwordx4 v[128:131], v2, s[12:15], s28 offen offset:0 nt
  buffer_load_dwordx4 v[132:135], v2, s[12:15], s28 offen offset:1024 nt
  buffer_load_dwordx4 v[136:139], v2, s[12:15], s28 offen offset:2048 nt
  buffer_load_dwordx4 v[140:143], v2, s[12:15], s28 offen offset:3072 nt
  s_waitcnt vmcnt(8)
  v_mov_b32_dpp v6, v36 row_newbcast:6 row_mask:0xf bank_mask:0xf
  v_lshlrev_b64 v[48:49], v4, v[8:9]
  v_lshlrev_b64 v[50:51], v5, v[8:9]
  v_mfma_f32_16x16x32_bf16 v[12:15], v[44:47], v[88:91], v[12:15]
  v_mov_b32_dpp v8, v37 row_newbcast:6 row_mask:0xf bank_mask:0xf
  v_lshlrev_b64 v[44:45], v4, v[6:7]
  v_lshlrev_b64 v[46:47], v5, v[6:7]
  v_mfma_f32_16x16x32_bf16 v[12:15], v[48:51], v[92:95], v[12:15]
  v_mov_b32_dpp v6, v38 row_newbcast:6 row_mask:0xf bank_mask:0xf
  v_lshlrev_b64 v[48:49], v4, v[8:9]
  v_lshlrev_b64 v[50:51], v5, v[8:9]
  v_mfma_f32_16x16x32_bf16 v[12:15], v[44:47], v[96:99], v[12:15]
  v_mov_b32_dpp v8, v39 row_newbcast:6 row_mask:0xf bank_mask:0xf
  v_lshlrev_b64 v[44:45], v4, v[6:7]
  v_lshlrev_b64 v[46:47], v5, v[6:7]
  v_mfma_f32_16x16x32_bf16 v[12:15], v[48:51], v[100:103], v[12:15]
  s_add_u32 s28, s24, 49152
  buffer_load_dwordx4 v[144:147], v2, s[12:15], s28 offen offset:0 nt
  buffer_load_dwordx4 v[148:151], v2, s[12:15], s28 offen offset:1024 nt
  buffer_load_dwordx4 v[152:155], v2, s[12:15], s28 offen offset:2048 nt
  buffer_load_dwordx4 v[156:159], v2, s[12:15], s28 offen offset:3072 nt
  s_waitcnt vmcnt(8)
  v_mov_b32_dpp v6, v36 row_newbcast:7 row_mask:0xf bank_mask:0xf
  v_lshlrev_b64 v[48:49], v4, v[8:9]
  v_lshlrev_b64 v[50:51], v5, v[8:9]
  v_mfma_f32_16x16x32_bf16 v[12:15], v[44:47], v[104:107], v[12:15]
  v_mov_b32_dpp v8, v37 row_newbcast:7 row_mask:0xf bank_mask:0xf
  v_lshlrev_b64 v[44:45], v4, v[6:7]
  v_lshlrev_b64 v[46:47], v5, v[6:7]
  v_mfma_f32_16x16x32_bf16 v[12:15], v[48:51], v[108:111], v[12:15]
  v_mov_b32_dpp v6, v38 row_newbcast:7 row_mask:0xf bank_mask:0xf
  v_lshlrev_b64 v[48:49], v4, v[8:9]
  v_lshlrev_b64 v[50:51], v5, v[8:9]
  v_mfma_f32_16x16x32_bf16 v[12:15], v[44:47], v[112:115], v[12:15]
  v_mov_b32_dpp v8, v39 row_newbcast:7 row_mask:0xf bank_mask:0xf
  v_lshlrev_b64 v[44:45], v4, v[6:7]
  v_lshlrev_b64 v[46:47], v5, v[6:7]
  v_mfma_f32_16x16x32_bf16 v[12:15], v[48:51], v[116:119], v[12:15]
  s_add_u32 s28, s24, 53248
  buffer_load_dwordx4 v[160:163], v2, s[12:15], s28 offen offset:0 nt
  buffer_load_dwordx4 v[164:167], v2, s[12:15], s28 offen offset:1024 nt
  buffer_load_dwordx4 v[168:171], v2, s[12:15], s28 offen offset:2048 nt
  buffer_load_dwordx4 v[172:175], v2, s[12:15], s28 offen offset:3072 nt
  s_waitcnt vmcnt(8)
  v_mov_b32_dpp v6, v32 row_newbcast:3 row_mask:0xf bank_mask:0xf
  v_lshlrev_b64 v[48:49], v4, v[8:9]
  v_lshlrev_b64 v[50:51], v5, v[8:9]
  v_mfma_f32_16x16x32_bf16 v[12:15], v[44:47], v[120:123], v[12:15]
  v_mov_b32_dpp v8, v33 row_newbcast:3 row_mask:0xf bank_mask:0xf
  v_lshlrev_b64 v[44:45], v4, v[6:7]
  v_lshlrev_b64 v[46:47], v5, v[6:7]
  v_mfma_f32_16x16x32_bf16 v[12:15], v[48:51], v[124:127], v[12:15]
  v_mov_b32_dpp v6, v34 row_newbcast:3 row_mask:0xf bank_mask:0xf
  v_lshlrev_b64 v[48:49], v4, v[8:9]
  v_lshlrev_b64 v[50:51], v5, v[8:9]
  v_mfma_f32_16x16x32_bf16 v[12:15], v[44:47], v[128:131], v[12:15]
  v_mov_b32_dpp v8, v35 row_newbcast:3 row_mask:0xf bank_mask:0xf
  v_lshlrev_b64 v[44:45], v4, v[6:7]
  v_lshlrev_b64 v[46:47], v5, v[6:7]
  v_mfma_f32_16x16x32_bf16 v[12:15], v[48:51], v[132:135], v[12:15]
  s_add_u32 s28, s24, 57344
  buffer_load_dwordx4 v[176:179], v2, s[12:15], s28 offen offset:0 nt
  buffer_load_dwordx4 v[180:183], v2, s[12:15], s28 offen offset:1024 nt
  buffer_load_dwordx4 v[184:187], v2, s[12:15], s28 offen offset:2048 nt
  buffer_load_dwordx4 v[188:191], v2, s[12:15], s28 offen offset:3072 nt
  s_waitcnt vmcnt(8)
  v_mov_b32_dpp v6, v32 row_newbcast:4 row_mask:0xf bank_mask:0xf
  v_lshlrev_b64 v[48:49], v4, v[8:9]
  v_lshlrev_b64 v[50:51], v5, v[8:9]
  v_mfma_f32_16x16x32_bf16 v[12:15], v[44:47], v[136:139], v[12:15]
  v_mov_b32_dpp v8, v33 row_newbcast:4 row_mask:0xf bank_mask:0xf
  v_lshlrev_b64 v[44:45], v4, v[6:7]
  v_lshlrev_b64 v[46:47], v5, v[6:7]
  v_mfma_f32_16x16x32_bf16 v[12:15], v[48:51], v[140:143], v[12:15]
  v_mov_b32_dpp v6, v34 row_newbcast:4 row_mask:0xf bank_mask:0xf
  v_lshlrev_b64 v[48:49], v4, v[8:9]
  v_lshlrev_b64 v[50:51], v5, v[8:9]
  v_mfma_f32_16x16x32_bf16 v[12:15], v[44:47], v[144:147], v[12:15]
  v_mov_b32_dpp v8, v35 row_newbcast:4 row_mask:0xf bank_mask:0xf
  v_lshlrev_b64 v[44:45], v4, v[6:7]
  v_lshlrev_b64 v[46:47], v5, v[6:7]
  v_mfma_f32_16x16x32_bf16 v[12:15], v[48:51], v[148:151], v[12:15]
  s_add_u32 s28, s24, 61440
  buffer_load_dwordx4 v[192:195], v2, s[12:15], s28 offen offset:0 nt
  buffer_load_dwordx4 v[196:199], v2, s[12:15], s28 offen offset:1024 nt
  buffer_load_dwordx4 v[200:203], v2, s[12:15], s28 offen offset:2048 nt
  buffer_load_dwordx4 v[204:207], v2, s[12:15], s28 offen offset:3072 nt
  s_waitcnt vmcnt(8)
  v_mov_b32_dpp v6, v32 row_newbcast:5 row_mask:0xf bank_mask:0xf
  v_lshlrev_b64 v[48:49], v4, v[8:9]
  v_lshlrev_b64 v[50:51], v5, v[8:9]
  v_mfma_f32_16x16x32_bf16 v[12:15], v[44:47], v[152:155], v[12:15]
  v_mov_b32_dpp v8, v33 row_newbcast:5 row_mask:0xf bank_mask:0xf
  v_lshlrev_b64 v[44:45], v4, v[6:7]
  v_lshlrev_b64 v[46:47], v5, v[6:7]
  v_mfma_f32_16x16x32_bf16 v[12:15], v[48:51], v[156:159], v[12:15]
  v_mov_b32_dpp v6, v34 row_newbcast:5 row_mask:0xf bank_mask:0xf
  v_lshlrev_b64 v[48:49], v4, v[8:9]
  v_lshlrev_b64 v[50:51], v5, v[8:9]
  v_mfma_f32_16x16x32_bf16 v[12:15], v[44:47], v[160:163], v[12:15]
  v_mov_b32_dpp v8, v35 row_newbcast:5 row_mask:0xf bank_mask:0xf
  v_lshlrev_b64 v[44:45], v4, v[6:7]
  v_lshlrev_b64 v[46:47], v5, v[6:7]
  v_mfma_f32_16x16x32_bf16 v[12:15], v[48:51], v[164:167], v[12:15]
  s_add_u32 s28, s24, 65536
  buffer_load_dwordx4 v[208:211], v2, s[12:15], s28 offen offset:0 nt
  buffer_load_dwordx4 v[212:215], v2, s[12:15], s28 offen offset:1024 nt
  buffer_load_dwordx4 v[216:219], v2, s[12:15], s28 offen offset:2048 nt
  buffer_load_dwordx4 v[220:223], v2, s[12:15], s28 offen offset:3072 nt
  s_waitcnt vmcnt(8)
  v_mov_b32_dpp v6, v32 row_newbcast:6 row_mask:0xf bank_mask:0xf
  v_lshlrev_b64 v[48:49], v4, v[8:9]
  v_lshlrev_b64 v[50:51], v5, v[8:9]
  v_mfma_f32_16x16x32_bf16 v[12:15], v[44:47], v[168:171], v[12:15]
  v_mov_b32_dpp v8, v33 row_newbcast:6 row_mask:0xf bank_mask:0xf
  v_lshlrev_b64 v[44:45], v4, v[6:7]
  v_lshlrev_b64 v[46:47], v5, v[6:7]
  v_mfma_f32_16x16x32_bf16 v[12:15], v[48:51], v[172:175], v[12:15]
  v_mov_b32_dpp v6, v34 row_newbcast:6 row_mask:0xf bank_mask:0xf
  v_lshlrev_b64 v[48:49], v4, v[8:9]
  v_lshlrev_b64 v[50:51], v5, v[8:9]
  v_mfma_f32_16x16x32_bf16 v[12:15], v[44:47], v[176:179], v[12:15]
  v_mov_b32_dpp v8, v35 row_newbcast:6 row_mask:0xf bank_mask:0xf
  v_lshlrev_b64 v[44:45], v4, v[6:7]
  v_lshlrev_b64 v[46:47], v5, v[6:7]
  v_mfma_f32_16x16x32_bf16 v[12:15], v[48:51], v[180:183], v[12:15]
  s_add_u32 s28, s24, 69632
  buffer_load_dwordx4 v[224:227], v2, s[12:15], s28 offen offset:0 nt
  buffer_load_dwordx4 v[228:231], v2, s[12:15], s28 offen offset:1024 nt
  buffer_load_dwordx4 v[232:235], v2, s[12:15], s28 offen offset:2048 nt
  buffer_load_dwordx4 v[236:239], v2, s[12:15], s28 offen offset:3072 nt
  s_waitcnt vmcnt(8)
  v_mov_b32_dpp v6, v32 row_newbcast:7 row_mask:0xf bank_mask:0xf
  v_lshlrev_b64 v[48:49], v4, v[8:9]
  v_lshlrev_b64 v[50:51], v5, v[8:9]
  v_mfma_f32_16x16x32_bf16 v[12:15], v[44:47], v[184:187], v[12:15]
  v_mov_b32_dpp v8, v33 row_newbcast:7 row_mask:0xf bank_mask:0xf
  v_lshlrev_b64 v[44:45], v4, v[6:7]
  v_lshlrev_b64 v[46:47], v5, v[6:7]
  v_mfma_f32_16x16x32_bf16 v[12:15], v[48:51], v[188:191], v[12:15]
  v_mov_b32_dpp v6, v34 row_newbcast:7 row_mask:0xf bank_mask:0xf
  v_lshlrev_b64 v[48:49], v4, v[8:9]
  v_lshlrev_b64 v[50:51], v5, v[8:9]
  v_mfma_f32_16x16x32_bf16 v[12:15], v[44:47], v[192:195], v[12:15]
  v_mov_b32_dpp v8, v35 row_newbcast:7 row_mask:0xf bank_mask:0xf
  v_lshlrev_b64 v[44:45], v4, v[6:7]
  v_lshlrev_b64 v[46:47], v5, v[6:7]
  v_mfma_f32_16x16x32_bf16 v[12:15], v[48:51], v[196:199], v[12:15]
  s_add_u32 s28, s24, 73728
  buffer_load_dwordx4 v[240:243], v2, s[12:15], s28 offen offset:0 nt
  buffer_load_dwordx4 v[244:247], v2, s[12:15], s28 offen offset:1024 nt
  buffer_load_dwordx4 v[248:251], v2, s[12:15], s28 offen offset:2048 nt
  buffer_load_dwordx4 v[252:255], v2, s[12:15], s28 offen offset:3072 nt
  s_waitcnt vmcnt(8)
  v_mov_b32_dpp v6, v40 row_newbcast:0 row_mask:0xf bank_mask:0xf
  v_lshlrev_b64 v[48:49], v4, v[8:9]
  v_lshlrev_b64 v[50:51], v5, v[8:9]
  v_mfma_f32_16x16x32_bf16 v[12:15], v[44:47], v[200:203], v[12:15]
  v_mov_b32_dpp v8, v41 row_newbcast:0 row_mask:0xf bank_mask:0xf
  v_lshlrev_b64 v[44:45], v4, v[6:7]
  v_lshlrev_b64 v[46:47], v5, v[6:7]
  v_mfma_f32_16x16x32_bf16 v[12:15], v[48:51], v[204:207], v[12:15]
  v_mov_b32_dpp v6, v42 row_newbcast:0 row_mask:0xf bank_mask:0xf
  v_lshlrev_b64 v[48:49], v4, v[8:9]
  v_lshlrev_b64 v[50:51], v5, v[8:9]
  v_mfma_f32_16x16x32_bf16 v[12:15], v[44:47], v[208:211], v[12:15]
  v_mov_b32_dpp v8, v43 row_newbcast:0 row_mask:0xf bank_mask:0xf
  v_lshlrev_b64 v[44:45], v4, v[6:7]
  v_lshlrev_b64 v[46:47], v5, v[6:7]
  v_mfma_f32_16x16x32_bf16 v[12:15], v[48:51], v[212:215], v[12:15]
  s_waitcnt vmcnt(4)
  v_mov_b32_dpp v6, v40 row_newbcast:1 row_mask:0xf bank_mask:0xf
  v_lshlrev_b64 v[48:49], v4, v[8:9]
  v_lshlrev_b64 v[50:51], v5, v[8:9]
  v_mfma_f32_16x16x32_bf16 v[12:15], v[44:47], v[216:219], v[12:15]
  v_mov_b32_dpp v8, v41 row_newbcast:1 row_mask:0xf bank_mask:0xf
  v_lshlrev_b64 v[44:45], v4, v[6:7]
  v_lshlrev_b64 v[46:47], v5, v[6:7]
  v_mfma_f32_16x16x32_bf16 v[12:15], v[48:51], v[220:223], v[12:15]
  v_mov_b32_dpp v6, v42 row_newbcast:1 row_mask:0xf bank_mask:0xf
  v_lshlrev_b64 v[48:49], v4, v[8:9]
  v_lshlrev_b64 v[50:51], v5, v[8:9]
  v_mfma_f32_16x16x32_bf16 v[12:15], v[44:47], v[224:227], v[12:15]
  v_mov_b32_dpp v8, v43 row_newbcast:1 row_mask:0xf bank_mask:0xf
  v_lshlrev_b64 v[44:45], v4, v[6:7]
  v_lshlrev_b64 v[46:47], v5, v[6:7]
  v_mfma_f32_16x16x32_bf16 v[12:15], v[48:51], v[228:231], v[12:15]
  s_waitcnt vmcnt(0)
  v_mov_b32_dpp v6, v40 row_newbcast:2 row_mask:0xf bank_mask:0xf
  v_lshlrev_b64 v[48:49], v4, v[8:9]
  v_lshlrev_b64 v[50:51], v5, v[8:9]
  v_mfma_f32_16x16x32_bf16 v[12:15], v[44:47], v[232:235], v[12:15]
  v_mov_b32_dpp v8, v41 row_newbcast:2 row_mask:0xf bank_mask:0xf
  v_lshlrev_b64 v[44:45], v4, v[6:7]
  v_lshlrev_b64 v[46:47], v5, v[6:7]
  v_mfma_f32_16x16x32_bf16 v[12:15], v[48:51], v[236:239], v[12:15]
  v_mov_b32_dpp v6, v42 row_newbcast:2 row_mask:0xf bank_mask:0xf
  v_lshlrev_b64 v[48:49], v4, v[8:9]
  v_lshlrev_b64 v[50:51], v5, v[8:9]
  v_mfma_f32_16x16x32_bf16 v[12:15], v[44:47], v[240:243], v[12:15]
  v_mov_b32_dpp v8, v43 row_newbcast:2 row_mask:0xf bank_mask:0xf
  v_lshlrev_b64 v[44:45], v4, v[6:7]
  v_lshlrev_b64 v[46:47], v5, v[6:7]
  v_mfma_f32_16x16x32_bf16 v[12:15], v[48:51], v[244:247], v[12:15]
  v_lshlrev_b64 v[48:49], v4, v[8:9]
  v_lshlrev_b64 v[50:51], v5, v[8:9]
  v_mfma_f32_16x16x32_bf16 v[12:15], v[44:47], v[248:251], v[12:15]
  s_nop 0
  v_mfma_f32_16x16x32_bf16 v[12:15], v[48:51], v[252:255], v[12:15]
  s_nop 6
  s_branch Lpvd_23
Lpvres_22:
  s_cmp_eq_u32 s27, 0
  s_cbranch_scc1 Lpv0_25
  ds_read_b128 v[16:19], v3 offset:4096
  ds_read_b128 v[20:23], v3 offset:5120
  ds_read_b128 v[24:27], v3 offset:6144
  ds_read_b128 v[28:31], v3 offset:7168
  v_mov_b32_dpp v6, v32 row_newbcast:0 row_mask:0xf bank_mask:0xf
  v_mov_b32_dpp v8, v33 row_newbcast:0 row_mask:0xf bank_mask:0xf
  v_lshlrev_b64 v[44:45], v4, v[6:7]
  v_lshlrev_b64 v[46:47], v5, v[6:7]
  v_mov_b32_dpp v6, v34 row_newbcast:0 row_mask:0xf bank_mask:0xf
  v_lshlrev_b64 v[48:49], v4, v[8:9]
  v_lshlrev_b64 v[50:51], v5, v[8:9]
  s_waitcnt lgkmcnt(3)
  v_mfma_f32_16x16x32_bf16 v[12:15], v[44:47], v[16:19], v[12:15]
  v_mov_b32_dpp v8, v35 row_newbcast:0 row_mask:0xf bank_mask:0xf
  v_lshlrev_b64 v[44:45], v4, v[6:7]
  v_lshlrev_b64 v[46:47], v5, v[6:7]
  s_waitcnt lgkmcnt(2)
  v_mfma_f32_16x16x32_bf16 v[12:15], v[48:51], v[20:23], v[12:15]
  v_lshlrev_b64 v[48:49], v4, v[8:9]
  v_lshlrev_b64 v[50:51], v5, v[8:9]
  s_waitcnt lgkmcnt(1)
  v_mfma_f32_16x16x32_bf16 v[12:15], v[44:47], v[24:27], v[12:15]
  s_waitcnt lgkmcnt(0)
  v_mfma_f32_16x16x32_bf16 v[12:15], v[48:51], v[28:31], v[12:15]
Lpv0_25:
  ds_read_b128 v[56:59], v3 offset:12288
  ds_read_b128 v[60:63], v3 offset:13312
  ds_read_b128 v[52:55], v3 offset:14336
  ds_read_b128 v[16:19], v3 offset:15360
  ds_read_b128 v[20:23], v3 offset:20480
  ds_read_b128 v[24:27], v3 offset:21504
  ds_read_b128 v[28:31], v3 offset:22528
  v_mov_b32_dpp v6, v36 row_newbcast:2 row_mask:0xf bank_mask:0xf
  v_mov_b32_dpp v8, v37 row_newbcast:2 row_mask:0xf bank_mask:0xf
  v_lshlrev_b64 v[44:45], v4, v[6:7]
  v_lshlrev_b64 v[46:47], v5, v[6:7]
  v_mov_b32_dpp v6, v38 row_newbcast:2 row_mask:0xf bank_mask:0xf
  v_lshlrev_b64 v[48:49], v4, v[8:9]
  v_lshlrev_b64 v[50:51], v5, v[8:9]
  v_mfma_f32_16x16x32_bf16 v[12:15], v[44:47], a[224:227], v[12:15]
  v_mov_b32_dpp v8, v32 row_newbcast:1 row_mask:0xf bank_mask:0xf
  v_lshlrev_b64 v[44:45], v4, v[6:7]
  v_lshlrev_b64 v[46:47], v5, v[6:7]
  v_mfma_f32_16x16x32_bf16 v[12:15], v[48:51], a[228:231], v[12:15]
  v_mov_b32_dpp v6, v39 row_newbcast:2 row_mask:0xf bank_mask:0xf
  v_lshlrev_b64 v[48:49], v4, v[8:9]
  v_lshlrev_b64 v[50:51], v5, v[8:9]
  v_mfma_f32_16x16x32_bf16 v[12:15], v[44:47], a[232:235], v[12:15]
  v_mov_b32_dpp v8, v36 row_newbcast:3 row_mask:0xf bank_mask:0xf
  v_lshlrev_b64 v[44:45], v4, v[6:7]
  v_lshlrev_b64 v[46:47], v5, v[6:7]
  s_waitcnt lgkmcnt(6)
  v_mfma_f32_16x16x32_bf16 v[12:15], v[48:51], v[56:59], v[12:15]
  ds_read_b128 v[56:59], v3 offset:23552
  v_mov_b32_dpp v6, v37 row_newbcast:3 row_mask:0xf bank_mask:0xf
  v_lshlrev_b64 v[48:49], v4, v[8:9]
  v_lshlrev_b64 v[50:51], v5, v[8:9]
  v_mfma_f32_16x16x32_bf16 v[12:15], v[44:47], a[236:239], v[12:15]
  v_mov_b32_dpp v8, v33 row_newbcast:1 row_mask:0xf bank_mask:0xf
  v_lshlrev_b64 v[44:45], v4, v[6:7]
  v_lshlrev_b64 v[46:47], v5, v[6:7]
  v_mfma_f32_16x16x32_bf16 v[12:15], v[48:51], a[240:243], v[12:15]
  v_mov_b32_dpp v6, v38 row_newbcast:3 row_mask:0xf bank_mask:0xf
  v_lshlrev_b64 v[48:49], v4, v[8:9]
  v_lshlrev_b64 v[50:51], v5, v[8:9]
  v_mfma_f32_16x16x32_bf16 v[12:15], v[44:47], a[244:247], v[12:15]
  v_mov_b32_dpp v8, v39 row_newbcast:3 row_mask:0xf bank_mask:0xf
  v_lshlrev_b64 v[44:45], v4, v[6:7]
  v_lshlrev_b64 v[46:47], v5, v[6:7]
  s_waitcnt lgkmcnt(6)
  v_mfma_f32_16x16x32_bf16 v[12:15], v[48:51], v[60:63], v[12:15]
  ds_read_b128 v[60:63], v3 offset:28672
  v_mov_b32_dpp v6, v36 row_newbcast:4 row_mask:0xf bank_mask:0xf
  v_lshlrev_b64 v[48:49], v4, v[8:9]
  v_lshlrev_b64 v[50:51], v5, v[8:9]
  v_mfma_f32_16x16x32_bf16 v[12:15], v[44:47], a[248:251], v[12:15]
  v_mov_b32_dpp v8, v34 row_newbcast:1 row_mask:0xf bank_mask:0xf
  v_lshlrev_b64 v[44:45], v4, v[6:7]
  v_lshlrev_b64 v[46:47], v5, v[6:7]
  v_mfma_f32_16x16x32_bf16 v[12:15], v[48:51], a[252:255], v[12:15]
  v_mov_b32_dpp v6, v37 row_newbcast:4 row_mask:0xf bank_mask:0xf
  v_lshlrev_b64 v[48:49], v4, v[8:9]
  v_lshlrev_b64 v[50:51], v5, v[8:9]
  v_mfma_f32_16x16x32_bf16 v[12:15], v[44:47], v[64:67], v[12:15]
  v_mov_b32_dpp v8, v38 row_newbcast:4 row_mask:0xf bank_mask:0xf
  v_lshlrev_b64 v[44:45], v4, v[6:7]
  v_lshlrev_b64 v[46:47], v5, v[6:7]
  s_waitcnt lgkmcnt(6)
  v_mfma_f32_16x16x32_bf16 v[12:15], v[48:51], v[52:55], v[12:15]
  ds_read_b128 v[52:55], v3 offset:29696
  v_mov_b32_dpp v6, v39 row_newbcast:4 row_mask:0xf bank_mask:0xf
  v_lshlrev_b64 v[48:49], v4, v[8:9]
  v_lshlrev_b64 v[50:51], v5, v[8:9]
  v_mfma_f32_16x16x32_bf16 v[12:15], v[44:47], v[68:71], v[12:15]
  v_mov_b32_dpp v8, v35 row_newbcast:1 row_mask:0xf bank_mask:0xf
  v_lshlrev_b64 v[44:45], v4, v[6:7]
  v_lshlrev_b64 v[46:47], v5, v[6:7]
  v_mfma_f32_16x16x32_bf16 v[12:15], v[48:51], v[72:75], v[12:15]
  v_mov_b32_dpp v6, v36 row_newbcast:5 row_mask:0xf bank_mask:0xf
  v_lshlrev_b64 v[48:49], v4, v[8:9]
  v_lshlrev_b64 v[50:51], v5, v[8:9]
  v_mfma_f32_16x16x32_bf16 v[12:15], v[44:47], v[76:79], v[12:15]
  v_mov_b32_dpp v8, v37 row_newbcast:5 row_mask:0xf bank_mask:0xf
  v_lshlrev_b64 v[44:45], v4, v[6:7]
  v_lshlrev_b64 v[46:47], v5, v[6:7]
  s_waitcnt lgkmcnt(6)
  v_mfma_f32_16x16x32_bf16 v[12:15], v[48:51], v[16:19], v[12:15]
  ds_read_b128 v[16:19], v3 offset:30720
  v_mov_b32_dpp v6, v38 row_newbcast:5 row_mask:0xf bank_mask:0xf
  v_lshlrev_b64 v[48:49], v4, v[8:9]
  v_lshlrev_b64 v[50:51], v5, v[8:9]
  v_mfma_f32_16x16x32_bf16 v[12:15], v[44:47], v[80:83], v[12:15]
  v_mov_b32_dpp v8, v32 row_newbcast:2 row_mask:0xf bank_mask:0xf
  v_lshlrev_b64 v[44:45], v4, v[6:7]
  v_lshlrev_b64 v[46:47], v5, v[6:7]
  v_mfma_f32_16x16x32_bf16 v[12:15], v[48:51], v[84:87], v[12:15]
  v_mov_b32_dpp v6, v39 row_newbcast:5 row_mask:0xf bank_mask:0xf
  v_lshlrev_b64 v[48:49], v4, v[8:9]
  v_lshlrev_b64 v[50:51], v5, v[8:9]
  v_mfma_f32_16x16x32_bf16 v[12:15], v[44:47], v[88:91], v[12:15]
  v_mov_b32_dpp v8, v36 row_newbcast:6 row_mask:0xf bank_mask:0xf
  v_lshlrev_b64 v[44:45], v4, v[6:7]
  v_lshlrev_b64 v[46:47], v5, v[6:7]
  s_waitcnt lgkmcnt(6)
  v_mfma_f32_16x16x32_bf16 v[12:15], v[48:51], v[20:23], v[12:15]
  ds_read_b128 v[20:23], v3 offset:31744
  v_mov_b32_dpp v6, v37 row_newbcast:6 row_mask:0xf bank_mask:0xf
  v_lshlrev_b64 v[48:49], v4, v[8:9]
  v_lshlrev_b64 v[50:51], v5, v[8:9]
  v_mfma_f32_16x16x32_bf16 v[12:15], v[44:47], v[92:95], v[12:15]
  v_mov_b32_dpp v8, v33 row_newbcast:2 row_mask:0xf bank_mask:0xf
  v_lshlrev_b64 v[44:45], v4, v[6:7]
  v_lshlrev_b64 v[46:47], v5, v[6:7]
  v_mfma_f32_16x16x32_bf16 v[12:15], v[48:51], v[96:99], v[12:15]
  v_mov_b32_dpp v6, v38 row_newbcast:6 row_mask:0xf bank_mask:0xf
  v_lshlrev_b64 v[48:49], v4, v[8:9]
  v_lshlrev_b64 v[50:51], v5, v[8:9]
  v_mfma_f32_16x16x32_bf16 v[12:15], v[44:47], v[100:103], v[12:15]
  v_mov_b32_dpp v8, v39 row_newbcast:6 row_mask:0xf bank_mask:0xf
  v_lshlrev_b64 v[44:45], v4, v[6:7]
  v_lshlrev_b64 v[46:47], v5, v[6:7]
  s_waitcnt lgkmcnt(6)
  v_mfma_f32_16x16x32_bf16 v[12:15], v[48:51], v[24:27], v[12:15]
  ds_read_b128 v[24:27], v3 offset:36864
  v_mov_b32_dpp v6, v36 row_newbcast:7 row_mask:0xf bank_mask:0xf
  v_lshlrev_b64 v[48:49], v4, v[8:9]
  v_lshlrev_b64 v[50:51], v5, v[8:9]
  v_mfma_f32_16x16x32_bf16 v[12:15], v[44:47], v[104:107], v[12:15]
  v_mov_b32_dpp v8, v34 row_newbcast:2 row_mask:0xf bank_mask:0xf
  v_lshlrev_b64 v[44:45], v4, v[6:7]
  v_lshlrev_b64 v[46:47], v5, v[6:7]
  v_mfma_f32_16x16x32_bf16 v[12:15], v[48:51], v[108:111], v[12:15]
  v_mov_b32_dpp v6, v37 row_newbcast:7 row_mask:0xf bank_mask:0xf
  v_lshlrev_b64 v[48:49], v4, v[8:9]
  v_lshlrev_b64 v[50:51], v5, v[8:9]
  v_mfma_f32_16x16x32_bf16 v[12:15], v[44:47], v[112:115], v[12:15]
  v_mov_b32_dpp v8, v38 row_newbcast:7 row_mask:0xf bank_mask:0xf
  v_lshlrev_b64 v[44:45], v4, v[6:7]
  v_lshlrev_b64 v[46:47], v5, v[6:7]
  s_waitcnt lgkmcnt(6)
  v_mfma_f32_16x16x32_bf16 v[12:15], v[48:51], v[28:31], v[12:15]
  ds_read_b128 v[28:31], v3 offset:37888
  v_mov_b32_dpp v6, v39 row_newbcast:7 row_mask:0xf bank_mask:0xf
  v_lshlrev_b64 v[48:49], v4, v[8:9]
  v_lshlrev_b64 v[50:51], v5, v[8:9]
  v_mfma_f32_16x16x32_bf16 v[12:15], v[44:47], v[116:119], v[12:15]
  v_mov_b32_dpp v8, v35 row_newbcast:2 row_mask:0xf bank_mask:0xf
  v_lshlrev_b64 v[44:45], v4, v[6:7]
  v_lshlrev_b64 v[46:47], v5, v[6:7]
  v_mfma_f32_16x16x32_bf16 v[12:15], v[48:51], v[120:123], v[12:15]
  v_mov_b32_dpp v6, v32 row_newbcast:3 row_mask:0xf bank_mask:0xf
  v_lshlrev_b64 v[48:49], v4, v[8:9]
  v_lshlrev_b64 v[50:51], v5, v[8:9]
  v_mfma_f32_16x16x32_bf16 v[12:15], v[44:47], v[124:127], v[12:15]
  v_mov_b32_dpp v8, v33 row_newbcast:3 row_mask:0xf bank_mask:0xf
  v_lshlrev_b64 v[44:45], v4, v[6:7]
  v_lshlrev_b64 v[46:47], v5, v[6:7]
  s_waitcnt lgkmcnt(6)
  v_mfma_f32_16x16x32_bf16 v[12:15], v[48:51], v[56:59], v[12:15]
  ds_read_b128 v[56:59], v3 offset:38912
  v_mov_b32_dpp v6, v34 row_newbcast:3 row_mask:0xf bank_mask:0xf
  v_lshlrev_b64 v[48:49], v4, v[8:9]
  v_lshlrev_b64 v[50:51], v5, v[8:9]
  v_mfma_f32_16x16x32_bf16 v[12:15], v[44:47], v[128:131], v[12:15]
  v_mov_b32_dpp v8, v36 row_newbcast:0 row_mask:0xf bank_mask:0xf
  v_lshlrev_b64 v[44:45], v4, v[6:7]
  v_lshlrev_b64 v[46:47], v5, v[6:7]
  v_mfma_f32_16x16x32_bf16 v[12:15], v[48:51], v[132:135], v[12:15]
  v_mov_b32_dpp v6, v35 row_newbcast:3 row_mask:0xf bank_mask:0xf
  v_lshlrev_b64 v[48:49], v4, v[8:9]
  v_lshlrev_b64 v[50:51], v5, v[8:9]
  v_mfma_f32_16x16x32_bf16 v[12:15], v[44:47], v[136:139], v[12:15]
  v_mov_b32_dpp v8, v32 row_newbcast:4 row_mask:0xf bank_mask:0xf
  v_lshlrev_b64 v[44:45], v4, v[6:7]
  v_lshlrev_b64 v[46:47], v5, v[6:7]
  s_waitcnt lgkmcnt(6)
  v_mfma_f32_16x16x32_bf16 v[12:15], v[48:51], v[60:63], v[12:15]
  ds_read_b128 v[60:63], v3 offset:39936
  v_mov_b32_dpp v6, v33 row_newbcast:4 row_mask:0xf bank_mask:0xf
  v_lshlrev_b64 v[48:49], v4, v[8:9]
  v_lshlrev_b64 v[50:51], v5, v[8:9]
  v_mfma_f32_16x16x32_bf16 v[12:15], v[44:47], v[140:143], v[12:15]
  v_mov_b32_dpp v8, v37 row_newbcast:0 row_mask:0xf bank_mask:0xf
  v_lshlrev_b64 v[44:45], v4, v[6:7]
  v_lshlrev_b64 v[46:47], v5, v[6:7]
  v_mfma_f32_16x16x32_bf16 v[12:15], v[48:51], v[144:147], v[12:15]
  v_mov_b32_dpp v6, v34 row_newbcast:4 row_mask:0xf bank_mask:0xf
  v_lshlrev_b64 v[48:49], v4, v[8:9]
  v_lshlrev_b64 v[50:51], v5, v[8:9]
  v_mfma_f32_16x16x32_bf16 v[12:15], v[44:47], v[148:151], v[12:15]
  v_mov_b32_dpp v8, v35 row_newbcast:4 row_mask:0xf bank_mask:0xf
  v_lshlrev_b64 v[44:45], v4, v[6:7]
  v_lshlrev_b64 v[46:47], v5, v[6:7]
  s_waitcnt lgkmcnt(6)
  v_mfma_f32_16x16x32_bf16 v[12:15], v[48:51], v[52:55], v[12:15]
  v_mov_b32_dpp v6, v32 row_newbcast:5 row_mask:0xf bank_mask:0xf
  v_lshlrev_b64 v[48:49], v4, v[8:9]
  v_lshlrev_b64 v[50:51], v5, v[8:9]
  v_mfma_f32_16x16x32_bf16 v[12:15], v[44:47], v[152:155], v[12:15]
  v_mov_b32_dpp v8, v38 row_newbcast:0 row_mask:0xf bank_mask:0xf
  v_lshlrev_b64 v[44:45], v4, v[6:7]
  v_lshlrev_b64 v[46:47], v5, v[6:7]
  v_mfma_f32_16x16x32_bf16 v[12:15], v[48:51], v[156:159], v[12:15]
  v_mov_b32_dpp v6, v33 row_newbcast:5 row_mask:0xf bank_mask:0xf
  v_lshlrev_b64 v[48:49], v4, v[8:9]
  v_lshlrev_b64 v[50:51], v5, v[8:9]
  v_mfma_f32_16x16x32_bf16 v[12:15], v[44:47], v[160:163], v[12:15]
  v_mov_b32_dpp v8, v34 row_newbcast:5 row_mask:0xf bank_mask:0xf
  v_lshlrev_b64 v[44:45], v4, v[6:7]
  v_lshlrev_b64 v[46:47], v5, v[6:7]
  s_waitcnt lgkmcnt(5)
  v_mfma_f32_16x16x32_bf16 v[12:15], v[48:51], v[16:19], v[12:15]
  v_mov_b32_dpp v6, v35 row_newbcast:5 row_mask:0xf bank_mask:0xf
  v_lshlrev_b64 v[48:49], v4, v[8:9]
  v_lshlrev_b64 v[50:51], v5, v[8:9]
  v_mfma_f32_16x16x32_bf16 v[12:15], v[44:47], v[164:167], v[12:15]
  v_mov_b32_dpp v8, v39 row_newbcast:0 row_mask:0xf bank_mask:0xf
  v_lshlrev_b64 v[44:45], v4, v[6:7]
  v_lshlrev_b64 v[46:47], v5, v[6:7]
  v_mfma_f32_16x16x32_bf16 v[12:15], v[48:51], v[168:171], v[12:15]
  v_mov_b32_dpp v6, v32 row_newbcast:6 row_mask:0xf bank_mask:0xf
  v_lshlrev_b64 v[48:49], v4, v[8:9]
  v_lshlrev_b64 v[50:51], v5, v[8:9]
  v_mfma_f32_16x16x32_bf16 v[12:15], v[44:47], v[172:175], v[12:15]
  v_mov_b32_dpp v8, v33 row_newbcast:6 row_mask:0xf bank_mask:0xf
  v_lshlrev_b64 v[44:45], v4, v[6:7]
  v_lshlrev_b64 v[46:47], v5, v[6:7]
  s_waitcnt lgkmcnt(4)
  v_mfma_f32_16x16x32_bf16 v[12:15], v[48:51], v[20:23], v[12:15]
  v_mov_b32_dpp v6, v34 row_newbcast:6 row_mask:0xf bank_mask:0xf
  v_lshlrev_b64 v[48:49], v4, v[8:9]
  v_lshlrev_b64 v[50:51], v5, v[8:9]
  v_mfma_f32_16x16x32_bf16 v[12:15], v[44:47], v[176:179], v[12:15]
  v_mov_b32_dpp v8, v36 row_newbcast:1 row_mask:0xf bank_mask:0xf
  v_lshlrev_b64 v[44:45], v4, v[6:7]
  v_lshlrev_b64 v[46:47], v5, v[6:7]
  v_mfma_f32_16x16x32_bf16 v[12:15], v[48:51], v[180:183], v[12:15]
  v_mov_b32_dpp v6, v35 row_newbcast:6 row_mask:0xf bank_mask:0xf
  v_lshlrev_b64 v[48:49], v4, v[8:9]
  v_lshlrev_b64 v[50:51], v5, v[8:9]
  v_mfma_f32_16x16x32_bf16 v[12:15], v[44:47], v[184:187], v[12:15]
  v_mov_b32_dpp v8, v32 row_newbcast:7 row_mask:0xf bank_mask:0xf
  v_lshlrev_b64 v[44:45], v4, v[6:7]
  v_lshlrev_b64 v[46:47], v5, v[6:7]
  s_waitcnt lgkmcnt(3)
  v_mfma_f32_16x16x32_bf16 v[12:15], v[48:51], v[24:27], v[12:15]
  v_mov_b32_dpp v6, v33 row_newbcast:7 row_mask:0xf bank_mask:0xf
  v_lshlrev_b64 v[48:49], v4, v[8:9]
  v_lshlrev_b64 v[50:51], v5, v[8:9]
  v_mfma_f32_16x16x32_bf16 v[12:15], v[44:47], v[188:191], v[12:15]
  v_mov_b32_dpp v8, v37 row_newbcast:1 row_mask:0xf bank_mask:0xf
  v_lshlrev_b64 v[44:45], v4, v[6:7]
  v_lshlrev_b64 v[46:47], v5, v[6:7]
  v_mfma_f32_16x16x32_bf16 v[12:15], v[48:51], v[192:195], v[12:15]
  v_mov_b32_dpp v6, v34 row_newbcast:7 row_mask:0xf bank_mask:0xf
  v_lshlrev_b64 v[48:49], v4, v[8:9]
  v_lshlrev_b64 v[50:51], v5, v[8:9]
  v_mfma_f32_16x16x32_bf16 v[12:15], v[44:47], v[196:199], v[12:15]
  v_mov_b32_dpp v8, v35 row_newbcast:7 row_mask:0xf bank_mask:0xf
  v_lshlrev_b64 v[44:45], v4, v[6:7]
  v_lshlrev_b64 v[46:47], v5, v[6:7]
  s_waitcnt lgkmcnt(2)
  v_mfma_f32_16x16x32_bf16 v[12:15], v[48:51], v[28:31], v[12:15]
  v_mov_b32_dpp v6, v40 row_newbcast:0 row_mask:0xf bank_mask:0xf
  v_lshlrev_b64 v[48:49], v4, v[8:9]
  v_lshlrev_b64 v[50:51], v5, v[8:9]
  v_mfma_f32_16x16x32_bf16 v[12:15], v[44:47], v[200:203], v[12:15]
  v_mov_b32_dpp v8, v38 row_newbcast:1 row_mask:0xf bank_mask:0xf
  v_lshlrev_b64 v[44:45], v4, v[6:7]
  v_lshlrev_b64 v[46:47], v5, v[6:7]
  v_mfma_f32_16x16x32_bf16 v[12:15], v[48:51], v[204:207], v[12:15]
  v_mov_b32_dpp v6, v41 row_newbcast:0 row_mask:0xf bank_mask:0xf
  v_lshlrev_b64 v[48:49], v4, v[8:9]
  v_lshlrev_b64 v[50:51], v5, v[8:9]
  v_mfma_f32_16x16x32_bf16 v[12:15], v[44:47], v[208:211], v[12:15]
  v_mov_b32_dpp v8, v42 row_newbcast:0 row_mask:0xf bank_mask:0xf
  v_lshlrev_b64 v[44:45], v4, v[6:7]
  v_lshlrev_b64 v[46:47], v5, v[6:7]
  s_waitcnt lgkmcnt(1)
  v_mfma_f32_16x16x32_bf16 v[12:15], v[48:51], v[56:59], v[12:15]
  v_mov_b32_dpp v6, v43 row_newbcast:0 row_mask:0xf bank_mask:0xf
  v_lshlrev_b64 v[48:49], v4, v[8:9]
  v_lshlrev_b64 v[50:51], v5, v[8:9]
  v_mfma_f32_16x16x32_bf16 v[12:15], v[44:47], v[212:215], v[12:15]
  v_mov_b32_dpp v8, v39 row_newbcast:1 row_mask:0xf bank_mask:0xf
  v_lshlrev_b64 v[44:45], v4, v[6:7]
  v_lshlrev_b64 v[46:47], v5, v[6:7]
  v_mfma_f32_16x16x32_bf16 v[12:15], v[48:51], v[216:219], v[12:15]
  v_mov_b32_dpp v6, v40 row_newbcast:1 row_mask:0xf bank_mask:0xf
  v_lshlrev_b64 v[48:49], v4, v[8:9]
  v_lshlrev_b64 v[50:51], v5, v[8:9]
  v_mfma_f32_16x16x32_bf16 v[12:15], v[44:47], v[220:223], v[12:15]
  v_mov_b32_dpp v8, v41 row_newbcast:1 row_mask:0xf bank_mask:0xf
  v_lshlrev_b64 v[44:45], v4, v[6:7]
  v_lshlrev_b64 v[46:47], v5, v[6:7]
  s_waitcnt lgkmcnt(0)
  v_mfma_f32_16x16x32_bf16 v[12:15], v[48:51], v[60:63], v[12:15]
  v_mov_b32_dpp v6, v42 row_newbcast:1 row_mask:0xf bank_mask:0xf
  v_lshlrev_b64 v[48:49], v4, v[8:9]
  v_lshlrev_b64 v[50:51], v5, v[8:9]
  v_mfma_f32_16x16x32_bf16 v[12:15], v[44:47], v[224:227], v[12:15]
  v_mov_b32_dpp v8, v43 row_newbcast:1 row_mask:0xf bank_mask:0xf
  v_lshlrev_b64 v[44:45], v4, v[6:7]
  v_lshlrev_b64 v[46:47], v5, v[6:7]
  v_mfma_f32_16x16x32_bf16 v[12:15], v[48:51], v[228:231], v[12:15]
  v_mov_b32_dpp v6, v40 row_newbcast:2 row_mask:0xf bank_mask:0xf
  v_lshlrev_b64 v[48:49], v4, v[8:9]
  v_lshlrev_b64 v[50:51], v5, v[8:9]
  v_mfma_f32_16x16x32_bf16 v[12:15], v[44:47], v[232:235], v[12:15]
  v_mov_b32_dpp v8, v41 row_newbcast:2 row_mask:0xf bank_mask:0xf
  v_lshlrev_b64 v[44:45], v4, v[6:7]
  v_lshlrev_b64 v[46:47], v5, v[6:7]
  v_mfma_f32_16x16x32_bf16 v[12:15], v[48:51], v[236:239], v[12:15]
  v_mov_b32_dpp v6, v42 row_newbcast:2 row_mask:0xf bank_mask:0xf
  v_lshlrev_b64 v[48:49], v4, v[8:9]
  v_lshlrev_b64 v[50:51], v5, v[8:9]
  v_mfma_f32_16x16x32_bf16 v[12:15], v[44:47], v[240:243], v[12:15]
  v_mov_b32_dpp v8, v43 row_newbcast:2 row_mask:0xf bank_mask:0xf
  v_lshlrev_b64 v[44:45], v4, v[6:7]
  v_lshlrev_b64 v[46:47], v5, v[6:7]
  v_mfma_f32_16x16x32_bf16 v[12:15], v[48:51], v[244:247], v[12:15]
  v_lshlrev_b64 v[48:49], v4, v[8:9]
  v_lshlrev_b64 v[50:51], v5, v[8:9]
  v_mfma_f32_16x16x32_bf16 v[12:15], v[44:47], v[248:251], v[12:15]
  s_nop 0
  v_mfma_f32_16x16x32_bf16 v[12:15], v[48:51], v[252:255], v[12:15]
Lpvd_23:
  v_and_b32 v47, 15, v0
  v_lshlrev_b32 v47, 5, v47
  v_lshrrev_b32 v48, 4, v0
  v_lshl_add_u32 v47, v48, 4, v47
  s_lshl_b32 s52, s3, 9
  s_add_u32 s52, s52, 147712
  v_add_u32 v47, s52, v47
  s_mov_b32 exec_hi, 0
  ds_write_b128 v47, v[12:15]
  s_mov_b64 exec, -1
  s_waitcnt lgkmcnt(0)
  s_barrier
  s_cmp_eq_u32 s3, 0
  s_cbranch_scc0 Lpub_26
  v_add_u32 v44, 147712, v2
  v_mov_b32 v45, 147456
  ds_read_b128 v[32:35], v45
  ds_read_b128 v[36:39], v45 offset:16
  ds_read_b128 v[48:51], v44 offset:0
  ds_read_b128 v[52:55], v44 offset:512
  ds_read_b128 v[56:59], v44 offset:1024
  ds_read_b128 v[60:63], v44 offset:1536
  s_mul_i32 s52, s26, 163840
  s_add_u32 s52, s52, s30
  s_waitcnt lgkmcnt(4)
  v_max_f32 v11, v32, v34
  v_max3_f32 v11, v11, v36, v38
  v_sub_f32 v32, v32, v11
  v_sub_f32 v34, v34, v11
  v_sub_f32 v36, v36, v11
  v_sub_f32 v38, v38, v11
  v_exp_f32 v32, v32
  v_exp_f32 v34, v34
  v_exp_f32 v36, v36
  v_exp_f32 v38, v38
  v_mul_f32 v10, v32, v33
  v_fmac_f32 v10, v34, v35
  v_fmac_f32 v10, v36, v37
  v_fmac_f32 v10, v38, v39
  s_waitcnt lgkmcnt(0)
  v_mul_f32 v48, v48, v32
  v_mul_f32 v49, v49, v32
  v_mul_f32 v50, v50, v32
  v_mul_f32 v51, v51, v32
  v_fmac_f32 v48, v52, v34
  v_fmac_f32 v49, v53, v34
  v_fmac_f32 v50, v54, v34
  v_fmac_f32 v51, v55, v34
  v_fmac_f32 v48, v56, v36
  v_fmac_f32 v49, v57, v36
  v_fmac_f32 v50, v58, v36
  v_fmac_f32 v51, v59, v36
  v_fmac_f32 v48, v60, v38
  v_fmac_f32 v49, v61, v38
  v_fmac_f32 v50, v62, v38
  v_fmac_f32 v51, v63, v38
  v_cmp_eq_u32 vcc, 32, v0
  s_nop 1
  v_cndmask_b32 v48, v48, v11, vcc
  v_cndmask_b32 v49, v49, v10, vcc
  s_mov_b32 exec_hi, 1
  buffer_store_dwordx4 v[48:51], v2, s[16:19], s52 offen sc0 sc1
  s_mov_b64 exec, -1
Lpub_26:
  s_barrier
  s_cmp_eq_u32 s26, 3
  s_cbranch_scc1 Laend_28
  s_cmp_eq_u32 s26, 1
  s_cbranch_scc0 Lnr_27
  s_add_u32 s28, s24, 61440
  s_waitcnt vmcnt(15)
  buffer_load_dwordx4 a[160:163], v1, s[8:11], s28 offen offset:0 nt
  s_waitcnt vmcnt(15)
  buffer_load_dwordx4 a[164:167], v1, s[8:11], s28 offen offset:128 nt
  s_waitcnt vmcnt(15)
  buffer_load_dwordx4 a[168:171], v1, s[8:11], s28 offen offset:512 nt
  s_waitcnt vmcnt(15)
  buffer_load_dwordx4 a[172:175], v1, s[8:11], s28 offen offset:640 nt
  s_add_u32 s28, s24, 65536
  s_waitcnt vmcnt(15)
  buffer_load_dwordx4 a[176:179], v1, s[8:11], s28 offen offset:0 nt
  s_waitcnt vmcnt(15)
  buffer_load_dwordx4 a[180:183], v1, s[8:11], s28 offen offset:128 nt
  s_waitcnt vmcnt(15)
  buffer_load_dwordx4 a[184:187], v1, s[8:11], s28 offen offset:512 nt
  s_waitcnt vmcnt(15)
  buffer_load_dwordx4 a[188:191], v1, s[8:11], s28 offen offset:640 nt
  s_add_u32 s28, s24, 69632
  s_waitcnt vmcnt(15)
  buffer_load_dwordx4 a[192:195], v1, s[8:11], s28 offen offset:0 nt
  s_waitcnt vmcnt(15)
  buffer_load_dwordx4 a[196:199], v1, s[8:11], s28 offen offset:128 nt
  s_waitcnt vmcnt(15)
  buffer_load_dwordx4 a[200:203], v1, s[8:11], s28 offen offset:512 nt
  s_waitcnt vmcnt(15)
  buffer_load_dwordx4 a[204:207], v1, s[8:11], s28 offen offset:640 nt
  s_add_u32 s28, s24, 73728
  s_waitcnt vmcnt(15)
  buffer_load_dwordx4 a[208:211], v1, s[8:11], s28 offen offset:0 nt
  s_waitcnt vmcnt(15)
  buffer_load_dwordx4 a[212:215], v1, s[8:11], s28 offen offset:128 nt
  s_waitcnt vmcnt(15)
  buffer_load_dwordx4 a[216:219], v1, s[8:11], s28 offen offset:512 nt
  s_waitcnt vmcnt(15)
  buffer_load_dwordx4 a[220:223], v1, s[8:11], s28 offen offset:640 nt
  s_cmp_eq_u32 s27, 0
  s_cbranch_scc1 Lopt_29
  s_add_u32 s28, s24, 0
  s_add_u32 m0, s25, 4096
  s_nop 0
  buffer_load_dwordx4 v2, s[12:15], s28 offen offset:0 nt lds
  buffer_load_dwordx4 v2, s[12:15], s28 offen offset:1024 nt lds
  buffer_load_dwordx4 v2, s[12:15], s28 offen offset:2048 nt lds
  buffer_load_dwordx4 v2, s[12:15], s28 offen offset:3072 nt lds
Lopt_29:
  s_add_u32 s28, s24, 4096
  s_add_u32 m0, s25, 12288
  s_nop 0
  buffer_load_dwordx4 v2, s[12:15], s28 offen offset:0 nt lds
  buffer_load_dwordx4 v2, s[12:15], s28 offen offset:1024 nt lds
  buffer_load_dwordx4 v2, s[12:15], s28 offen offset:2048 nt lds
  buffer_load_dwordx4 v2, s[12:15], s28 offen offset:3072 nt lds
  s_add_u32 s28, s24, 8192
  s_add_u32 m0, s25, 20480
  s_nop 0
  buffer_load_dwordx4 v2, s[12:15], s28 offen offset:0 nt lds
  buffer_load_dwordx4 v2, s[12:15], s28 offen offset:1024 nt lds
  buffer_load_dwordx4 v2, s[12:15], s28 offen offset:2048 nt lds
  buffer_load_dwordx4 v2, s[12:15], s28 offen offset:3072 nt lds
  s_mov_b32 s52, 1
  s_lshl_b32 s35, s52, 8
  s_add_u32 s35, s35, 155648
  s_lshl_b32 s52, s52, 13
  s_lshl_b32 s31, s32, 8
  s_add_u32 s31, s31, s52
  s_add_u32 s31, s31, 655360
  v_bfe_u32 v56, v0, 3, 1
  v_lshlrev_b32 v56, 6, v56
  v_lshrrev_b32 v57, 4, v0
  v_lshl_add_u32 v56, v57, 4, v56
  v_add_u32 v56, s35, v56
  v_xor_b32 v57, 64, v56
  ds_read_b128 v[16:19], v56 offset:0
  ds_read_b128 v[20:23], v56 offset:128
  ds_read_b128 v[24:27], v57 offset:0
  ds_read_b128 v[28:31], v57 offset:128
  s_waitcnt lgkmcnt(0)
  s_waitcnt vmcnt(8)
  s_mov_b32 s26, 2
  s_branch L_pass
Lnr_27:
  s_cmp_eq_u32 s26, 0
  s_cbranch_scc0 Lp2_30
  s_add_u32 s54, s24, 0x4000000
  s_mov_b32 s52, 1
  s_lshl_b32 s35, s52, 8
  s_add_u32 s35, s35, 155648
  s_lshl_b32 s52, s52, 13
  s_lshl_b32 s31, s32, 8
  s_add_u32 s31, s31, s52
  s_add_u32 s31, s31, 655360
  s_lshl_b32 s52, s3, 6
  s_add_u32 s52, s52, s31
  s_add_u32 s52, s4, s52
  s_addc_u32 s53, s5, 0
  s_mov_b32 s34, 0
Lqf_32:
  s_load_dwordx16 s[36:51], s[52:53], 0x0 glc
  s_add_u32 s34, s34, 1
  s_waitcnt lgkmcnt(0)
  s_cmp_ge_u32 s34, 20000
  s_cbranch_scc1 Lqo_33_t
  s_cmp_eq_u32 s36, -1
  s_cbranch_scc1 Lqf_32_s
  s_cmp_eq_u32 s51, -1
  s_cbranch_scc0 Lqo_33_t
Lqf_32_s:
  s_sleep 1
  s_branch Lqf_32
Lqo_33_t:
  v_writelane_b32 v11, s36, 0
  v_writelane_b32 v11, s37, 1
  v_writelane_b32 v11, s38, 2
  v_writelane_b32 v11, s39, 3
  v_writelane_b32 v11, s40, 4
  v_writelane_b32 v11, s41, 5
  v_writelane_b32 v11, s42, 6
  v_writelane_b32 v11, s43, 7
  v_writelane_b32 v11, s44, 8
  v_writelane_b32 v11, s45, 9
  v_writelane_b32 v11, s46, 10
  v_writelane_b32 v11, s47, 11
  v_writelane_b32 v11, s48, 12
  v_writelane_b32 v11, s49, 13
  v_writelane_b32 v11, s50, 14
  v_writelane_b32 v11, s51, 15
  s_cmp_ge_u32 s34, 20000
  s_cbranch_scc1 Lqo_33
  s_mov_b32 exec_lo, 0xffff
  s_mov_b32 exec_hi, 0
  v_cmp_eq_u32 vcc, -1, v11
  s_mov_b64 exec, -1
  s_nop 2
  s_cbranch_vccnz Lqf_32
Lqo_33:
  s_lshl_b32 s52, s3, 6
  s_add_u32 s52, s52, s35
  v_lshl_add_u32 v10, v0, 2, s52
  s_mov_b32 exec_lo, 0xffff
  s_mov_b32 exec_hi, 0
  ds_write_b32 v10, v11
  s_mov_b64 exec, -1
  s_waitcnt lgkmcnt(0)
  s_barrier
  v_bfe_u32 v56, v0, 3, 1
  v_lshlrev_b32 v56, 6, v56
  v_lshrrev_b32 v57, 4, v0
  v_lshl_add_u32 v56, v57, 4, v56
  v_add_u32 v56, s35, v56
  v_xor_b32 v57, 64, v56
  ds_read_b128 v[16:19], v56 offset:0
  ds_read_b128 v[20:23], v56 offset:128
  ds_read_b128 v[24:27], v57 offset:0
  ds_read_b128 v[28:31], v57 offset:128
  s_waitcnt lgkmcnt(0)
  s_mov_b32 s34, 0
  v_mov_b32 v11, 872448
Lgate_34:
  buffer_load_dword v10, v11, s[16:19], 0 offen sc1
  s_waitcnt vmcnt(0)
  v_readfirstlane_b32 s52, v10
  s_nop 0
  s_cmp_lg_u32 s52, -1
  s_nop 1
  s_cbranch_scc1 Lgateok_35
  s_sleep 4
  s_add_u32 s34, s34, 1
  s_cmp_lt_u32 s34, 20000
  s_cbranch_scc1 Lgate_34
Lgateok_35:
  s_add_u32 s28, s54, 12288
  buffer_load_dwordx4 v[56:59], v1, s[8:11], s28 offen offset:0 nt
  buffer_load_dwordx4 v[60:63], v1, s[8:11], s28 offen offset:128 nt
  s_add_u32 s28, s54, 12288
  buffer_load_dwordx4 v[32:35], v1, s[8:11], s28 offen offset:512 nt
  buffer_load_dwordx4 v[40:43], v1, s[8:11], s28 offen offset:640 nt
  s_add_u32 s28, s54, 16384
  buffer_load_dwordx4 v[12:15], v1, s[8:11], s28 offen offset:0 nt
  buffer_load_dwordx4 v[52:55], v1, s[8:11], s28 offen offset:128 nt
  v_mov_b32 v36, 0xff800000
  v_mov_b32 v37, 0xff800000
  v_mov_b32 v38, 0xff800000
  v_mov_b32 v39, 0xff800000
  s_waitcnt vmcnt(4)
  v_mfma_f32_16x16x32_bf16 v[44:47], v[56:59], v[16:19], 0
  v_mfma_f32_16x16x32_bf16 v[44:47], v[60:63], v[20:23], v[44:47]
  s_add_u32 s28, s54, 16384
  buffer_load_dwordx4 v[56:59], v1, s[8:11], s28 offen offset:512 nt
  buffer_load_dwordx4 v[60:63], v1, s[8:11], s28 offen offset:640 nt
  s_waitcnt vmcnt(4)
  v_mfma_f32_16x16x32_bf16 v[48:51], v[32:35], v[24:27], 0
  v_mfma_f32_16x16x32_bf16 v[48:51], v[40:43], v[28:31], v[48:51]
  s_add_u32 s28, s54, 20480
  buffer_load_dwordx4 v[32:35], v1, s[8:11], s28 offen offset:0 nt
  buffer_load_dwordx4 v[40:43], v1, s[8:11], s28 offen offset:128 nt
  v_cndmask_b32 v36, v36, v44, s[56:57]
  v_cndmask_b32 v37, v37, v45, s[56:57]
  v_cndmask_b32 v38, v38, v46, s[56:57]
  v_cndmask_b32 v39, v39, v47, s[56:57]
  s_waitcnt vmcnt(4)
  v_mfma_f32_16x16x32_bf16 v[44:47], v[12:15], v[16:19], 0
  v_mfma_f32_16x16x32_bf16 v[44:47], v[52:55], v[20:23], v[44:47]
  s_add_u32 s28, s54, 20480
  buffer_load_dwordx4 v[12:15], v1, s[8:11], s28 offen offset:512 nt
  buffer_load_dwordx4 v[52:55], v1, s[8:11], s28 offen offset:640 nt
  v_cndmask_b32 v36, v36, v48, s[58:59]
  v_cndmask_b32 v37, v37, v49, s[58:59]
  v_cndmask_b32 v38, v38, v50, s[58:59]
  v_cndmask_b32 v39, v39, v51, s[58:59]
  s_waitcnt vmcnt(4)
  v_mfma_f32_16x16x32_bf16 v[48:51], v[56:59], v[24:27], 0
  v_mfma_f32_16x16x32_bf16 v[48:51], v[60:63], v[28:31], v[48:51]
  s_add_u32 s28, s54, 24576
  buffer_load_dwordx4 v[56:59], v1, s[8:11], s28 offen offset:0 nt
  buffer_load_dwordx4 v[60:63], v1, s[8:11], s28 offen offset:128 nt
  v_cndmask_b32 v36, v36, v44, s[60:61]
  v_cndmask_b32 v37, v37, v45, s[60:61]
  v_cndmask_b32 v38, v38, v46, s[60:61]
  v_cndmask_b32 v39, v39, v47, s[60:61]
  s_waitcnt vmcnt(4)
  v_mfma_f32_16x16x32_bf16 v[44:47], v[32:35], v[16:19], 0
  v_mfma_f32_16x16x32_bf16 v[44:47], v[40:43], v[20:23], v[44:47]
  s_add_u32 s28, s54, 24576
  buffer_load_dwordx4 v[32:35], v1, s[8:11], s28 offen offset:512 nt
  buffer_load_dwordx4 v[40:43], v1, s[8:11], s28 offen offset:640 nt
  v_cndmask_b32 v36, v36, v48, s[62:63]
  v_cndmask_b32 v37, v37, v49, s[62:63]
  v_cndmask_b32 v38, v38, v50, s[62:63]
  v_cndmask_b32 v39, v39, v51, s[62:63]
  s_waitcnt vmcnt(4)
  v_mfma_f32_16x16x32_bf16 v[48:51], v[12:15], v[24:27], 0
  v_mfma_f32_16x16x32_bf16 v[48:51], v[52:55], v[28:31], v[48:51]
  s_add_u32 s28, s54, 28672
  buffer_load_dwordx4 v[12:15], v1, s[8:11], s28 offen offset:0 nt
  buffer_load_dwordx4 v[52:55], v1, s[8:11], s28 offen offset:128 nt
  v_cndmask_b32 v36, v36, v44, s[64:65]
  v_cndmask_b32 v37, v37, v45, s[64:65]
  v_cndmask_b32 v38, v38, v46, s[64:65]
  v_cndmask_b32 v39, v39, v47, s[64:65]
  s_waitcnt vmcnt(4)
  v_mfma_f32_16x16x32_bf16 v[44:47], v[56:59], v[16:19], 0
  v_mfma_f32_16x16x32_bf16 v[44:47], v[60:63], v[20:23], v[44:47]
  s_add_u32 s28, s54, 28672
  buffer_load_dwordx4 v[56:59], v1, s[8:11], s28 offen offset:512 nt
  buffer_load_dwordx4 v[60:63], v1, s[8:11], s28 offen offset:640 nt
  v_cndmask_b32 v36, v36, v48, s[66:67]
  v_cndmask_b32 v37, v37, v49, s[66:67]
  v_cndmask_b32 v38, v38, v50, s[66:67]
  v_cndmask_b32 v39, v39, v51, s[66:67]
  s_waitcnt vmcnt(4)
  v_mfma_f32_16x16x32_bf16 v[48:51], v[32:35], v[24:27], 0
  v_mfma_f32_16x16x32_bf16 v[48:51], v[40:43], v[28:31], v[48:51]
  s_add_u32 s28, s54, 32768
  buffer_load_dwordx4 v[32:35], v1, s[8:11], s28 offen offset:0 nt
  buffer_load_dwordx4 v[40:43], v1, s[8:11], s28 offen offset:128 nt
  v_cndmask_b32 v36, v36, v44, s[68:69]
  v_cndmask_b32 v37, v37, v45, s[68:69]
  v_cndmask_b32 v38, v38, v46, s[68:69]
  v_cndmask_b32 v39, v39, v47, s[68:69]
  s_waitcnt vmcnt(4)
  v_mfma_f32_16x16x32_bf16 v[44:47], v[12:15], v[16:19], 0
  v_mfma_f32_16x16x32_bf16 v[44:47], v[52:55], v[20:23], v[44:47]
  s_add_u32 s28, s54, 32768
  buffer_load_dwordx4 v[12:15], v1, s[8:11], s28 offen offset:512 nt
  buffer_load_dwordx4 v[52:55], v1, s[8:11], s28 offen offset:640 nt
  v_cndmask_b32 v36, v36, v48, s[70:71]
  v_cndmask_b32 v37, v37, v49, s[70:71]
  v_cndmask_b32 v38, v38, v50, s[70:71]
  v_cndmask_b32 v39, v39, v51, s[70:71]
  s_waitcnt vmcnt(4)
  v_mfma_f32_16x16x32_bf16 v[48:51], v[56:59], v[24:27], 0
  v_mfma_f32_16x16x32_bf16 v[48:51], v[60:63], v[28:31], v[48:51]
  s_add_u32 s28, s54, 36864
  buffer_load_dwordx4 v[56:59], v1, s[8:11], s28 offen offset:0 nt
  buffer_load_dwordx4 v[60:63], v1, s[8:11], s28 offen offset:128 nt
  v_cndmask_b32 v36, v36, v44, s[72:73]
  v_cndmask_b32 v37, v37, v45, s[72:73]
  v_cndmask_b32 v38, v38, v46, s[72:73]
  v_cndmask_b32 v39, v39, v47, s[72:73]
  s_waitcnt vmcnt(4)
  v_mfma_f32_16x16x32_bf16 v[44:47], v[32:35], v[16:19], 0
  v_mfma_f32_16x16x32_bf16 v[44:47], v[40:43], v[20:23], v[44:47]
  s_add_u32 s28, s54, 36864
  buffer_load_dwordx4 v[32:35], v1, s[8:11], s28 offen offset:512 nt
  buffer_load_dwordx4 v[40:43], v1, s[8:11], s28 offen offset:640 nt
  v_cndmask_b32 v36, v36, v48, s[74:75]
  v_cndmask_b32 v37, v37, v49, s[74:75]
  v_cndmask_b32 v38, v38, v50, s[74:75]
  v_cndmask_b32 v39, v39, v51, s[74:75]
  s_waitcnt vmcnt(4)
  v_mfma_f32_16x16x32_bf16 v[48:51], v[12:15], v[24:27], 0
  v_mfma_f32_16x16x32_bf16 v[48:51], v[52:55], v[28:31], v[48:51]
  s_add_u32 s28, s54, 40960
  buffer_load_dwordx4 v[12:15], v1, s[8:11], s28 offen offset:0 nt
  buffer_load_dwordx4 v[52:55], v1, s[8:11], s28 offen offset:128 nt
  v_cndmask_b32 v36, v36, v44, s[76:77]
  v_cndmask_b32 v37, v37, v45, s[76:77]
  v_cndmask_b32 v38, v38, v46, s[76:77]
  v_cndmask_b32 v39, v39, v47, s[76:77]
  s_waitcnt vmcnt(4)
  v_mfma_f32_16x16x32_bf16 v[44:47], v[56:59], v[16:19], 0
  v_mfma_f32_16x16x32_bf16 v[44:47], v[60:63], v[20:23], v[44:47]
  s_add_u32 s28, s54, 40960
  buffer_load_dwordx4 v[56:59], v1, s[8:11], s28 offen offset:512 nt
  buffer_load_dwordx4 v[60:63], v1, s[8:11], s28 offen offset:640 nt
  v_cndmask_b32 v36, v36, v48, s[78:79]
  v_cndmask_b32 v37, v37, v49, s[78:79]
  v_cndmask_b32 v38, v38, v50, s[78:79]
  v_cndmask_b32 v39, v39, v51, s[78:79]
  s_waitcnt vmcnt(4)
  v_mfma_f32_16x16x32_bf16 v[48:51], v[32:35], v[24:27], 0
  v_mfma_f32_16x16x32_bf16 v[48:51], v[40:43], v[28:31], v[48:51]
  v_cndmask_b32 v36, v36, v44, s[80:81]
  v_cndmask_b32 v37, v37, v45, s[80:81]
  v_cndmask_b32 v38, v38, v46, s[80:81]
  v_cndmask_b32 v39, v39, v47, s[80:81]
  s_waitcnt vmcnt(2)
  v_mfma_f32_16x16x32_bf16 v[44:47], v[12:15], v[16:19], 0
  v_mfma_f32_16x16x32_bf16 v[44:47], v[52:55], v[20:23], v[44:47]
  s_nop 0
  v_cndmask_b32 v36, v36, v48, s[82:83]
  v_cndmask_b32 v37, v37, v49, s[82:83]
  v_cndmask_b32 v38, v38, v50, s[82:83]
  v_cndmask_b32 v39, v39, v51, s[82:83]
  s_waitcnt vmcnt(0)
  v_mfma_f32_16x16x32_bf16 v[48:51], v[56:59], v[24:27], 0
  v_mfma_f32_16x16x32_bf16 v[48:51], v[60:63], v[28:31], v[48:51]
  v_cndmask_b32 v36, v36, v44, s[84:85]
  v_cndmask_b32 v37, v37, v45, s[84:85]
  v_cndmask_b32 v38, v38, v46, s[84:85]
  v_cndmask_b32 v39, v39, v47, s[84:85]
  s_nop 3
  v_cndmask_b32 v36, v36, v48, s[86:87]
  v_cndmask_b32 v37, v37, v49, s[86:87]
  v_cndmask_b32 v38, v38, v50, s[86:87]
  v_cndmask_b32 v39, v39, v51, s[86:87]
  s_lshl_b32 s52, s3, 10
  s_add_u32 s52, s52, 151552
  v_add_u32 v11, s52, v2
  ds_write_b128 v11, v[36:39]
  s_waitcnt lgkmcnt(0)
  s_branch Lqp_31
Lp2_30:
  s_mov_b32 s34, 0
  v_mov_b32 v11, 872452
Lgate_36:
  buffer_load_dword v10, v11, s[16:19], 0 offen sc1
  s_waitcnt vmcnt(0)
  v_readfirstlane_b32 s52, v10
  s_nop 0
  s_cmp_lg_u32 s52, -1
  s_nop 1
  s_cbranch_scc1 Lgateok_37
  s_sleep 4
  s_add_u32 s34, s34, 1
  s_cmp_lt_u32 s34, 20000
  s_cbranch_scc1 Lgate_36
Lgateok_37:
  s_add_u32 s28, s24, 12288
  s_add_u32 m0, s25, 24576
  s_add_u32 s51, s28, 0
  buffer_load_dwordx4 v1, s[8:11], s51 offen nt lds
  s_add_u32 m0, s25, 25600
  s_add_u32 s51, s28, 128
  buffer_load_dwordx4 v1, s[8:11], s51 offen nt lds
  s_add_u32 m0, s25, 26624
  s_add_u32 s51, s28, 512
  buffer_load_dwordx4 v1, s[8:11], s51 offen nt lds
  s_add_u32 m0, s25, 27648
  s_add_u32 s51, s28, 640
  buffer_load_dwordx4 v1, s[8:11], s51 offen nt lds
  s_add_u32 s28, s24, 16384
  s_add_u32 m0, s25, 32768
  s_add_u32 s51, s28, 0
  buffer_load_dwordx4 v1, s[8:11], s51 offen nt lds
  s_add_u32 m0, s25, 33792
  s_add_u32 s51, s28, 128
  buffer_load_dwordx4 v1, s[8:11], s51 offen nt lds
  s_add_u32 m0, s25, 34816
  s_add_u32 s51, s28, 512
  buffer_load_dwordx4 v1, s[8:11], s51 offen nt lds
  s_add_u32 m0, s25, 35840
  s_add_u32 s51, s28, 640
  buffer_load_dwordx4 v1, s[8:11], s51 offen nt lds
  s_add_u32 s28, s24, 20480
  buffer_load_dwordx4 a[0:3], v1, s[8:11], s28 offen offset:0 nt
  buffer_load_dwordx4 a[4:7], v1, s[8:11], s28 offen offset:128 nt
  buffer_load_dwordx4 a[8:11], v1, s[8:11], s28 offen offset:512 nt
  buffer_load_dwordx4 a[12:15], v1, s[8:11], s28 offen offset:640 nt
  s_add_u32 s28, s24, 24576
  buffer_load_dwordx4 a[16:19], v1, s[8:11], s28 offen offset:0 nt
  buffer_load_dwordx4 a[20:23], v1, s[8:11], s28 offen offset:128 nt
  buffer_load_dwordx4 a[24:27], v1, s[8:11], s28 offen offset:512 nt
  buffer_load_dwordx4 a[28:31], v1, s[8:11], s28 offen offset:640 nt
  s_add_u32 s28, s24, 28672
  buffer_load_dwordx4 a[32:35], v1, s[8:11], s28 offen offset:0 nt
  buffer_load_dwordx4 a[36:39], v1, s[8:11], s28 offen offset:128 nt
  buffer_load_dwordx4 a[40:43], v1, s[8:11], s28 offen offset:512 nt
  buffer_load_dwordx4 a[44:47], v1, s[8:11], s28 offen offset:640 nt
  s_add_u32 s28, s24, 32768
  buffer_load_dwordx4 a[48:51], v1, s[8:11], s28 offen offset:0 nt
  buffer_load_dwordx4 a[52:55], v1, s[8:11], s28 offen offset:128 nt
  buffer_load_dwordx4 a[56:59], v1, s[8:11], s28 offen offset:512 nt
  buffer_load_dwordx4 a[60:63], v1, s[8:11], s28 offen offset:640 nt
  s_add_u32 s28, s24, 36864
  buffer_load_dwordx4 a[64:67], v1, s[8:11], s28 offen offset:0 nt
  buffer_load_dwordx4 a[68:71], v1, s[8:11], s28 offen offset:128 nt
  buffer_load_dwordx4 a[72:75], v1, s[8:11], s28 offen offset:512 nt
  buffer_load_dwordx4 a[76:79], v1, s[8:11], s28 offen offset:640 nt
  s_add_u32 s28, s24, 40960
  buffer_load_dwordx4 a[80:83], v1, s[8:11], s28 offen offset:0 nt
  buffer_load_dwordx4 a[84:87], v1, s[8:11], s28 offen offset:128 nt
  buffer_load_dwordx4 a[88:91], v1, s[8:11], s28 offen offset:512 nt
  buffer_load_dwordx4 a[92:95], v1, s[8:11], s28 offen offset:640 nt
Lqp_31:
  s_lshr_b32 s52, s26, 1
  s_add_u32 s52, s52, 2
  s_lshl_b32 s35, s52, 8
  s_add_u32 s35, s35, 155648
  s_lshl_b32 s52, s52, 13
  s_lshl_b32 s31, s32, 8
  s_add_u32 s31, s31, s52
  s_add_u32 s31, s31, 655360
  s_lshl_b32 s52, s3, 6
  s_add_u32 s52, s52, s31
  s_add_u32 s52, s4, s52
  s_addc_u32 s53, s5, 0
  s_mov_b32 s34, 0
Lqf_38:
  s_load_dwordx16 s[36:51], s[52:53], 0x0 glc
  s_add_u32 s34, s34, 1
  s_waitcnt lgkmcnt(0)
  s_cmp_ge_u32 s34, 20000
  s_cbranch_scc1 Lqo_39_t
  s_cmp_eq_u32 s36, -1
  s_cbranch_scc1 Lqf_38_s
  s_cmp_eq_u32 s51, -1
  s_cbranch_scc0 Lqo_39_t
Lqf_38_s:
  s_sleep 1
  s_branch Lqf_38
Lqo_39_t:
  v_writelane_b32 v11, s36, 0
  v_writelane_b32 v11, s37, 1
  v_writelane_b32 v11, s38, 2
  v_writelane_b32 v11, s39, 3
  v_writelane_b32 v11, s40, 4
  v_writelane_b32 v11, s41, 5
  v_writelane_b32 v11, s42, 6
  v_writelane_b32 v11, s43, 7
  v_writelane_b32 v11, s44, 8
  v_writelane_b32 v11, s45, 9
  v_writelane_b32 v11, s46, 10
  v_writelane_b32 v11, s47, 11
  v_writelane_b32 v11, s48, 12
  v_writelane_b32 v11, s49, 13
  v_writelane_b32 v11, s50, 14
  v_writelane_b32 v11, s51, 15
  s_cmp_ge_u32 s34, 20000
  s_cbranch_scc1 Lqo_39
  s_mov_b32 exec_lo, 0xffff
  s_mov_b32 exec_hi, 0
  v_cmp_eq_u32 vcc, -1, v11
  s_mov_b64 exec, -1
  s_nop 2
  s_cbranch_vccnz Lqf_38
Lqo_39:
  s_lshl_b32 s52, s3, 6
  s_add_u32 s52, s52, s35
  v_lshl_add_u32 v10, v0, 2, s52
  s_mov_b32 exec_lo, 0xffff
  s_mov_b32 exec_hi, 0
  ds_write_b32 v10, v11
  s_mov_b64 exec, -1
  s_waitcnt lgkmcnt(0)
  s_barrier
  v_bfe_u32 v56, v0, 3, 1
  v_lshlrev_b32 v56, 6, v56
  v_lshrrev_b32 v57, 4, v0
  v_lshl_add_u32 v56, v57, 4, v56
  v_add_u32 v56, s35, v56
  v_xor_b32 v57, 64, v56
  ds_read_b128 v[16:19], v56 offset:0
  ds_read_b128 v[20:23], v56 offset:128
  ds_read_b128 v[24:27], v57 offset:0
  ds_read_b128 v[28:31], v57 offset:128
  s_waitcnt lgkmcnt(0)
  s_add_u32 s26, s26, 1
  s_branch L_pass
Laend_28:
  s_branch L_exit
L_chain:
  s_lshr_b32 s4, s2, 3
  s_lshr_b32 s5, s4, 2
  s_and_b32 s6, s4, 3
  s_waitcnt lgkmcnt(0)
  s_mov_b32 s16, s80
  s_and_b32 s17, s81, 0xffff
  s_mov_b32 s18, 0x200000
  s_mov_b32 s19, 0x20000
  s_mov_b32 s20, s78
  s_and_b32 s21, s79, 0xffff
  s_mov_b32 s22, 0x100
  s_mov_b32 s23, 0x20000
  s_mov_b32 s24, s62
  s_and_b32 s25, s63, 0xffff
  s_mov_b32 s26, 0x480000
  s_mov_b32 s27, 0x20000
  s_mov_b32 s28, s64
  s_and_b32 s29, s65, 0xffff
  s_mov_b32 s30, 0x480000
  s_mov_b32 s31, 0x20000
  s_mov_b32 s32, s68
  s_and_b32 s33, s69, 0xffff
  s_mov_b32 s34, 0x510000
  s_mov_b32 s35, 0x20000
  s_mov_b32 s36, s72
  s_and_b32 s37, s73, 0xffff
  s_mov_b32 s38, 0x510000
  s_mov_b32 s39, 0x20000
  s_mov_b32 s40, s56
  s_and_b32 s41, s57, 0xffff
  s_mov_b32 s42, 0x900
  s_mov_b32 s43, 0x20000
  s_mov_b32 s44, s70
  s_and_b32 s45, s71, 0xffff
  s_mov_b32 s46, 0x2400
  s_mov_b32 s47, 0x20000
  s_mov_b32 s48, s74
  s_and_b32 s49, s75, 0xffff
  s_mov_b32 s50, 0x480
  s_mov_b32 s51, 0x20000
  s_mov_b32 s52, s76
  s_and_b32 s53, s77, 0xffff
  s_mov_b32 s54, 0x900
  s_mov_b32 s55, 0x20000
  s_mov_b32 s60, 0xffff0000
  s_mov_b32 s61, 0
  s_mov_b32 s62, 0
  s_mov_b32 s63, 0x0000ffff
  s_mov_b32 s64, 0
  s_mov_b32 s65, 0xffff0000
  s_mov_b32 s66, 0
  s_mov_b32 s67, -1
  s_lshl_b32 s56, s3, 11
  s_mul_i32 s57, s3, 9216
  s_cmp_eq_u32 s3, 1
  s_cbranch_scc0 Lcp_40
  s_getpc_b64 s[70:71]
Lpc_41:
  s_add_u32 s70, s70, L_chain_rest-Lpc_41
  s_addc_u32 s71, s71, 0
  s_mov_b32 s72, L_exit-L_chain_rest-4
  v_lshlrev_b32 v46, 7, v0
  v_min_u32 v46, s72, v46
  global_load_dword a252, v46, s[70:71]
  v_lshlrev_b32 v46, 7, v0
  v_add_u32 v46, 8192, v46
  v_min_u32 v46, s72, v46
  global_load_dword a253, v46, s[70:71]
  v_lshlrev_b32 v46, 7, v0
  v_add_u32 v46, 16384, v46
  v_min_u32 v46, s72, v46
  global_load_dword a254, v46, s[70:71]
  v_lshlrev_b32 v46, 7, v0
  v_add_u32 v46, 24576, v46
  v_min_u32 v46, s72, v46
  global_load_dword a255, v46, s[70:71]
Lcp_40:
L_chain_rest:
  s_mul_i32 s10, s3, 576
  v_lshl_add_u32 v1, v0, 4, s10
  v_lshrrev_b32 v12, 4, v0
  v_lshlrev_b32 v2, 4, v12
  v_add_u32 v2, 151552, v2
  v_lshl_add_u32 v3, v0, 4, s56
  v_bfe_u32 v43, v0, 2, 2
  v_lshrrev_b32 v42, 4, v0
  v_lshl_add_u32 v42, v42, 3, v43
  v_lshlrev_b32 v10, 8, v42
  v_bfe_u32 v42, v0, 1, 1
  v_lshlrev_b32 v43, 1, v43
  s_lshl_b32 s10, s3, 2
  v_add_u32 v42, s10, v42
  v_xor_b32 v42, v42, v43
  v_lshl_add_u32 v10, v42, 4, v10
  v_and_b32 v42, 1, v0
  v_lshl_add_u32 v10, v42, 3, v10
  v_add_u32 v10, 57344, v10
  v_mov_b32 v16, -1
  v_mov_b32 v17, -1
  v_mov_b32 v18, -1
  v_mov_b32 v19, -1
  v_lshlrev_b32 v15, 4, v0
  s_lshl_b32 s10, s3, 13
  s_lshl_b32 s11, s4, 8
  s_add_u32 s10, s10, s11
  s_add_u32 s10, s10, 655360
  s_mov_b32 exec_lo, 0xffff
  s_mov_b32 exec_hi, 0
  buffer_store_dwordx4 v[16:19], v15, s[16:19], s10 offen sc0 sc1
  s_mul_i32 s10, s3, 18432
  s_mul_i32 s11, s5, 2304
  s_add_u32 s10, s10, s11
  s_mul_i32 s11, s6, 576
  s_add_u32 s10, s10, s11
  s_add_u32 s11, s10, 798720
  s_add_u32 s10, s10, 688128
  s_mov_b32 exec_lo, -1
  s_mov_b32 exec_hi, 0xf
  buffer_store_dwordx4 v[16:19], v15, s[16:19], s10 offen sc0 sc1
  buffer_store_dwordx4 v[16:19], v15, s[16:19], s11 offen sc0 sc1
  v_lshrrev_b32 v20, 1, v1
  buffer_load_dwordx2 v[22:23], v20, s[40:43], 0 offen
  buffer_load_dwordx2 v[24:25], v20, s[40:43], 0 offen offset:1152
  s_mul_i32 s10, s3, 9216
  s_mul_i32 s11, s4, 288
  s_add_u32 s10, s10, s11
  s_add_u32 s10, s10, 761856
  s_mov_b32 exec_lo, 0x3ffff
  s_mov_b32 exec_hi, 0
  buffer_store_dwordx4 v[16:19], v15, s[16:19], s10 offen sc0 sc1
  s_lshl_b32 s10, s4, 7
  s_add_u32 s10, s10, 872448
  s_mov_b32 exec_lo, 0x1
  s_mov_b32 exec_hi, 0
  buffer_store_dwordx4 v[16:19], v15, s[16:19], s10 offen sc0 sc1
  s_mov_b64 exec, -1
  s_mul_i32 s10, s4, 288
  s_lshl_b32 s11, s3, 6
  s_add_u32 s10, s10, s11
  v_lshlrev_b32 v21, 1, v0
  buffer_load_ushort v9, v21, s[44:47], s10 offen
  s_mul_i32 s10, s6, 288
  s_add_u32 s10, s10, s11
  buffer_load_ushort v26, v21, s[48:51], s10 offen
  v_lshrrev_b32 v42, 4, v0
  v_mul_u32_u24 v37, 8192, v42
  v_lshlrev_b32 v42, 1, v42
  v_and_b32 v43, 15, v0
  v_xor_b32 v42, v42, v43
  v_lshlrev_b32 v42, 4, v42
  v_add_u32 v36, v37, v42
  v_xor_b32 v42, 128, v42
  v_add_u32 v37, v37, v42
  v_lshrrev_b32 v38, 1, v0
  v_mul_u32_u24 v38, 8192, v38
  v_and_b32 v42, 1, v0
  v_lshl_add_u32 v38, v42, 4, v38
  s_lshl_b32 s15, s4, 8
  s_mul_i32 s11, s3, 65536
  s_add_u32 s11, s11, s15
  s_add_u32 m0, s56, 57344
  s_add_u32 s10, s11, 0
  buffer_load_dwordx4 v36, s[24:27], s10 offen nt lds
  s_add_u32 m0, s56, 58368
  s_add_u32 s10, s11, 32768
  buffer_load_dwordx4 v37, s[24:27], s10 offen nt lds
  s_mul_i32 s11, s3, 65536
  s_add_u32 s11, s11, s15
  s_add_u32 m0, s56, 65536
  s_add_u32 s10, s11, 262144
  buffer_load_dwordx4 v36, s[24:27], s10 offen nt lds
  s_add_u32 m0, s56, 66560
  s_add_u32 s10, s11, 294912
  buffer_load_dwordx4 v37, s[24:27], s10 offen nt lds
  s_mul_i32 s11, s3, 65536
  s_add_u32 s11, s11, s15
  s_add_u32 m0, s56, 73728
  s_add_u32 s10, s11, 524288
  buffer_load_dwordx4 v36, s[24:27], s10 offen nt lds
  s_add_u32 m0, s56, 74752
  s_add_u32 s10, s11, 557056
  buffer_load_dwordx4 v37, s[24:27], s10 offen nt lds
  s_mul_i32 s11, s3, 65536
  s_add_u32 s11, s11, s15
  s_add_u32 m0, s56, 81920
  s_add_u32 s10, s11, 786432
  buffer_load_dwordx4 v36, s[24:27], s10 offen nt lds
  s_add_u32 m0, s56, 82944
  s_add_u32 s10, s11, 819200
  buffer_load_dwordx4 v37, s[24:27], s10 offen nt lds
  s_mul_i32 s11, s3, 65536
  s_add_u32 s11, s11, s15
  s_add_u32 m0, s56, 90112
  s_add_u32 s10, s11, 1048576
  buffer_load_dwordx4 v36, s[24:27], s10 offen nt lds
  s_add_u32 m0, s56, 91136
  s_add_u32 s10, s11, 1081344
  buffer_load_dwordx4 v37, s[24:27], s10 offen nt lds
  s_mul_i32 s11, s3, 65536
  s_add_u32 s11, s11, s15
  s_add_u32 m0, s56, 98304
  s_add_u32 s10, s11, 1310720
  buffer_load_dwordx4 v36, s[24:27], s10 offen nt lds
  s_add_u32 m0, s56, 99328
  s_add_u32 s10, s11, 1343488
  buffer_load_dwordx4 v37, s[24:27], s10 offen nt lds
  s_mul_i32 s11, s3, 65536
  s_add_u32 s11, s11, s15
  s_add_u32 m0, s56, 106496
  s_add_u32 s10, s11, 1572864
  buffer_load_dwordx4 v36, s[24:27], s10 offen nt lds
  s_add_u32 m0, s56, 107520
  s_add_u32 s10, s11, 1605632
  buffer_load_dwordx4 v37, s[24:27], s10 offen nt lds
  s_mul_i32 s11, s3, 65536
  s_add_u32 s11, s11, s15
  s_add_u32 m0, s56, 114688
  s_add_u32 s10, s11, 1835008
  buffer_load_dwordx4 v36, s[24:27], s10 offen nt lds
  s_add_u32 m0, s56, 115712
  s_add_u32 s10, s11, 1867776
  buffer_load_dwordx4 v37, s[24:27], s10 offen nt lds
  s_mul_i32 s11, s3, 65536
  s_add_u32 s11, s11, s15
  s_add_u32 m0, s56, 122880
  s_add_u32 s10, s11, 2097152
  buffer_load_dwordx4 v36, s[24:27], s10 offen nt lds
  s_add_u32 m0, s56, 123904
  s_add_u32 s10, s11, 2129920
  buffer_load_dwordx4 v37, s[24:27], s10 offen nt lds
  s_mul_i32 s11, s3, 65536
  s_add_u32 s11, s11, s15
  s_add_u32 m0, s56, 131072
  s_add_u32 s10, s11, 2359296
  buffer_load_dwordx4 v36, s[24:27], s10 offen nt lds
  s_add_u32 m0, s56, 132096
  s_add_u32 s10, s11, 2392064
  buffer_load_dwordx4 v37, s[24:27], s10 offen nt lds
  s_mul_i32 s11, s3, 65536
  s_add_u32 s11, s11, s15
  s_add_u32 m0, s56, 139264
  s_add_u32 s10, s11, 2621440
  buffer_load_dwordx4 v36, s[24:27], s10 offen nt lds
  s_add_u32 m0, s56, 140288
  s_add_u32 s10, s11, 2654208
  buffer_load_dwordx4 v37, s[24:27], s10 offen nt lds
  s_mul_i32 s11, s3, 65536
  s_add_u32 s11, s11, s15
  s_add_u32 m0, s56, 0
  s_add_u32 s10, s11, 2883584
  buffer_load_dwordx4 v36, s[24:27], s10 offen nt lds
  s_add_u32 m0, s56, 1024
  s_add_u32 s10, s11, 2916352
  buffer_load_dwordx4 v37, s[24:27], s10 offen nt lds
  s_mul_i32 s11, s3, 65536
  s_add_u32 s11, s11, s15
  s_add_u32 m0, s56, 8192
  s_add_u32 s10, s11, 3145728
  buffer_load_dwordx4 v36, s[24:27], s10 offen nt lds
  s_add_u32 m0, s56, 9216
  s_add_u32 s10, s11, 3178496
  buffer_load_dwordx4 v37, s[24:27], s10 offen nt lds
  s_mul_i32 s11, s3, 65536
  s_add_u32 s11, s11, s15
  s_add_u32 m0, s56, 16384
  s_add_u32 s10, s11, 3407872
  buffer_load_dwordx4 v36, s[24:27], s10 offen nt lds
  s_add_u32 m0, s56, 17408
  s_add_u32 s10, s11, 3440640
  buffer_load_dwordx4 v37, s[24:27], s10 offen nt lds
  s_mul_i32 s11, s3, 65536
  s_add_u32 s11, s11, s15
  s_add_u32 m0, s56, 24576
  s_add_u32 s10, s11, 3670016
  buffer_load_dwordx4 v36, s[24:27], s10 offen nt lds
  s_add_u32 m0, s56, 25600
  s_add_u32 s10, s11, 3702784
  buffer_load_dwordx4 v37, s[24:27], s10 offen nt lds
  s_mul_i32 s11, s3, 65536
  s_add_u32 s11, s11, s15
  s_add_u32 m0, s56, 32768
  s_add_u32 s10, s11, 3932160
  buffer_load_dwordx4 v36, s[24:27], s10 offen nt lds
  s_add_u32 m0, s56, 33792
  s_add_u32 s10, s11, 3964928
  buffer_load_dwordx4 v37, s[24:27], s10 offen nt lds
  s_mul_i32 s11, s3, 65536
  s_add_u32 s11, s11, s15
  s_add_u32 m0, s56, 40960
  s_add_u32 s10, s11, 4194304
  buffer_load_dwordx4 v36, s[24:27], s10 offen nt lds
  s_add_u32 m0, s56, 41984
  s_add_u32 s10, s11, 4227072
  buffer_load_dwordx4 v37, s[24:27], s10 offen nt lds
  s_mul_i32 s11, s3, 65536
  s_add_u32 s11, s11, s15
  s_add_u32 m0, s56, 49152
  s_add_u32 s10, s11, 4456448
  buffer_load_dwordx4 v36, s[24:27], s10 offen nt lds
  s_add_u32 m0, s56, 50176
  s_add_u32 s10, s11, 4489216
  buffer_load_dwordx4 v37, s[24:27], s10 offen nt lds
  s_waitcnt vmcnt(36)
  v_lshlrev_b32 v9, 16, v9
  v_mov_b32 v21, 0
  s_cmp_eq_u32 s5, 0
  s_cselect_b64 vcc, -1, 0
  v_cndmask_b32 v26, v21, v26, vcc
  v_or_b32 v9, v9, v26
  v_add_u32 v20, 157696, v20
  s_mov_b32 exec_lo, -1
  s_mov_b32 exec_hi, 0xf
  ds_write_b64 v20, v[22:23]
  ds_write_b64 v20, v[24:25] offset:1152
  s_mov_b64 exec, -1
  v_mov_b32 v12, 0x3f803f80
  v_mov_b32 v13, 0x3f803f80
  v_lshrrev_b32 v14, 1, v1
  v_add_u32 v14, 151552, v14
  s_mov_b32 exec_lo, -1
  s_mov_b32 exec_hi, 0xf
  ds_write_b64 v14, v[12:13]
  s_mov_b64 exec, -1
  s_waitcnt lgkmcnt(0)
  s_barrier
  s_cmp_eq_u32 s3, 0
  s_cbranch_scc0 Lci_42
  s_getreg_b32 s10, hwreg(HW_REG_XCC_ID)
  s_and_b32 s10, s10, 7
  s_lshl_b32 s10, s10, 3
  s_lshl_b64 s[70:71], 1, s10
  v_mov_b32 v12, s70
  v_mov_b32 v13, s71
  v_mov_b32 v14, 128
  s_mov_b64 exec, 1
  buffer_atomic_add_x2 v[12:13], v14, s[20:23], 0 offen sc1
  s_mov_b64 exec, -1
Lci_42:
  s_waitcnt vmcnt(14)
  s_barrier
  v_bfe_u32 v43, v0, 2, 2
  v_lshrrev_b32 v42, 4, v0
  v_lshl_add_u32 v42, v42, 3, v43
  v_lshlrev_b32 v44, 8, v42
  v_bfe_u32 v42, v0, 1, 1
  v_lshlrev_b32 v43, 1, v43
  s_lshl_b32 s10, s3, 2
  v_add_u32 v42, s10, v42
  v_xor_b32 v42, v42, v43
  v_lshl_add_u32 v44, v42, 4, v44
  v_and_b32 v42, 1, v0
  v_lshl_add_u32 v44, v42, 3, v44
  v_add_u32 v44, 57344, v44
  v_xor_b32 v45, 32, v44
  v_xor_b32 v46, 128, v44
  v_xor_b32 v47, 160, v44
  ds_read_b64_tr_b16 v[48:49], v44 offset:0
  ds_read_b64_tr_b16 v[50:51], v46 offset:1024
  ds_read_b64_tr_b16 v[52:53], v45 offset:0
  ds_read_b64_tr_b16 v[54:55], v47 offset:1024
  ds_read_b64_tr_b16 v[56:57], v44 offset:8192
  ds_read_b64_tr_b16 v[58:59], v46 offset:9216
  ds_read_b64_tr_b16 v[60:61], v45 offset:8192
  ds_read_b64_tr_b16 v[62:63], v47 offset:9216
  ds_read_b64_tr_b16 v[64:65], v44 offset:16384
  ds_read_b64_tr_b16 v[66:67], v46 offset:17408
  ds_read_b64_tr_b16 v[68:69], v45 offset:16384
  ds_read_b64_tr_b16 v[70:71], v47 offset:17408
  s_waitcnt lgkmcnt(0)
  ds_read_b64_tr_b16 v[72:73], v44 offset:24576
  ds_read_b64_tr_b16 v[74:75], v46 offset:25600
  ds_read_b64_tr_b16 v[76:77], v45 offset:24576
  ds_read_b64_tr_b16 v[78:79], v47 offset:25600
  ds_read_b64_tr_b16 v[80:81], v44 offset:32768
  ds_read_b64_tr_b16 v[82:83], v46 offset:33792
  ds_read_b64_tr_b16 v[84:85], v45 offset:32768
  ds_read_b64_tr_b16 v[86:87], v47 offset:33792
  ds_read_b64_tr_b16 v[88:89], v44 offset:40960
  ds_read_b64_tr_b16 v[90:91], v46 offset:41984
  ds_read_b64_tr_b16 v[92:93], v45 offset:40960
  ds_read_b64_tr_b16 v[94:95], v47 offset:41984
  s_waitcnt lgkmcnt(0)
  s_waitcnt lgkmcnt(0)
  v_bfe_u32 v43, v0, 2, 2
  v_lshrrev_b32 v42, 4, v0
  v_lshl_add_u32 v42, v42, 3, v43
  v_lshlrev_b32 v44, 8, v42
  v_bfe_u32 v42, v0, 1, 1
  v_lshlrev_b32 v43, 1, v43
  s_lshl_b32 s10, s3, 2
  v_add_u32 v42, s10, v42
  v_xor_b32 v42, v42, v43
  v_lshl_add_u32 v44, v42, 4, v44
  v_and_b32 v42, 1, v0
  v_lshl_add_u32 v44, v42, 3, v44
  v_add_u32 v44, 106496, v44
  v_xor_b32 v45, 32, v44
  v_xor_b32 v46, 128, v44
  v_xor_b32 v47, 160, v44
  ds_read_b64_tr_b16 v[96:97], v44 offset:0
  ds_read_b64_tr_b16 v[98:99], v46 offset:1024
  ds_read_b64_tr_b16 v[100:101], v45 offset:0
  ds_read_b64_tr_b16 v[102:103], v47 offset:1024
  ds_read_b64_tr_b16 v[104:105], v44 offset:8192
  ds_read_b64_tr_b16 v[106:107], v46 offset:9216
  ds_read_b64_tr_b16 v[108:109], v45 offset:8192
  ds_read_b64_tr_b16 v[110:111], v47 offset:9216
  ds_read_b64_tr_b16 v[112:113], v44 offset:16384
  ds_read_b64_tr_b16 v[114:115], v46 offset:17408
  ds_read_b64_tr_b16 v[116:117], v45 offset:16384
  ds_read_b64_tr_b16 v[118:119], v47 offset:17408
  s_waitcnt lgkmcnt(0)
  ds_read_b64_tr_b16 v[120:121], v44 offset:24576
  ds_read_b64_tr_b16 v[122:123], v46 offset:25600
  ds_read_b64_tr_b16 v[124:125], v45 offset:24576
  ds_read_b64_tr_b16 v[126:127], v47 offset:25600
  ds_read_b64_tr_b16 v[128:129], v44 offset:32768
  ds_read_b64_tr_b16 v[130:131], v46 offset:33792
  ds_read_b64_tr_b16 v[132:133], v45 offset:32768
  ds_read_b64_tr_b16 v[134:135], v47 offset:33792
  s_waitcnt lgkmcnt(0)
  s_barrier
  s_lshl_b32 s10, s3, 6
  v_add_u32 v42, s10, v0
  v_add_u32 v42, 0, v42
  v_mul_u32_u24 v39, 3641, v42
  v_lshrrev_b32 v39, 16, v39
  v_mul_u32_u24 v43, 18, v39
  v_sub_u32 v42, v42, v43
  v_mul_u32_u24 v39, 1152, v39
  v_lshl_add_u32 v39, v42, 4, v39
  s_lshl_b32 s10, s3, 6
  v_add_u32 v42, s10, v0
  v_add_u32 v42, 256, v42
  v_mul_u32_u24 v40, 3641, v42
  v_lshrrev_b32 v40, 16, v40
  v_mul_u32_u24 v43, 18, v40
  v_sub_u32 v42, v42, v43
  v_mul_u32_u24 v40, 1152, v40
  v_lshl_add_u32 v40, v42, 4, v40
  s_lshl_b32 s10, s3, 6
  v_add_u32 v42, s10, v0
  v_add_u32 v42, 512, v42
  v_mul_u32_u24 v41, 3641, v42
  v_lshrrev_b32 v41, 16, v41
  v_mul_u32_u24 v43, 18, v41
  v_sub_u32 v42, v42, v43
  v_mul_u32_u24 v41, 1152, v41
  v_lshl_add_u32 v41, v42, 4, v41
  s_mul_i32 s15, s5, 589824
  s_mul_i32 s10, s6, 288
  s_add_u32 s15, s15, s10
  s_add_u32 s10, s15, 0
  s_lshl_b32 s11, s3, 10
  s_add_u32 m0, s11, 114688
  s_nop 0
  buffer_load_dwordx4 v39, s[28:31], s10 offen nt lds
  s_add_u32 m0, s11, 118784
  s_nop 0
  buffer_load_dwordx4 v40, s[28:31], s10 offen nt lds
  s_cmp_eq_u32 s3, 0
  s_cbranch_scc0 Ld9_43
  s_mov_b32 m0, 122880
  s_nop 0
  buffer_load_dwordx4 v41, s[28:31], s10 offen nt lds
Ld9_43:
  s_add_u32 s10, s15, 147456
  s_lshl_b32 s11, s3, 10
  s_add_u32 m0, s11, 123904
  s_nop 0
  buffer_load_dwordx4 v39, s[28:31], s10 offen nt lds
  s_add_u32 m0, s11, 128000
  s_nop 0
  buffer_load_dwordx4 v40, s[28:31], s10 offen nt lds
  s_cmp_eq_u32 s3, 0
  s_cbranch_scc0 Ld9_44
  s_mov_b32 m0, 132096
  s_nop 0
  buffer_load_dwordx4 v41, s[28:31], s10 offen nt lds
Ld9_44:
  s_add_u32 s10, s15, 294912
  s_lshl_b32 s11, s3, 10
  s_add_u32 m0, s11, 133120
  s_nop 0
  buffer_load_dwordx4 v39, s[28:31], s10 offen nt lds
  s_add_u32 m0, s11, 137216
  s_nop 0
  buffer_load_dwordx4 v40, s[28:31], s10 offen nt lds
  s_cmp_eq_u32 s3, 0
  s_cbranch_scc0 Ld9_45
  s_mov_b32 m0, 141312
  s_nop 0
  buffer_load_dwordx4 v41, s[28:31], s10 offen nt lds
Ld9_45:
  s_add_u32 s10, s15, 442368
  s_lshl_b32 s11, s3, 10
  s_add_u32 m0, s11, 142336
  s_nop 0
  buffer_load_dwordx4 v39, s[28:31], s10 offen nt lds
  s_add_u32 m0, s11, 146432
  s_nop 0
  buffer_load_dwordx4 v40, s[28:31], s10 offen nt lds
  s_cmp_eq_u32 s3, 0
  s_cbranch_scc0 Ld9_46
  s_mov_b32 m0, 150528
  s_nop 0
  buffer_load_dwordx4 v41, s[28:31], s10 offen nt lds
Ld9_46:
  s_add_u32 s10, s15, 36864
  s_lshl_b32 s11, s3, 10
  s_add_u32 m0, s11, 57344
  s_nop 0
  buffer_load_dwordx4 v39, s[28:31], s10 offen nt lds
  s_add_u32 m0, s11, 61440
  s_nop 0
  buffer_load_dwordx4 v40, s[28:31], s10 offen nt lds
  s_cmp_eq_u32 s3, 0
  s_cbranch_scc0 Ld9_47
  s_mov_b32 m0, 65536
  s_nop 0
  buffer_load_dwordx4 v41, s[28:31], s10 offen nt lds
Ld9_47:
  s_add_u32 s10, s15, 184320
  s_lshl_b32 s11, s3, 10
  s_add_u32 m0, s11, 66560
  s_nop 0
  buffer_load_dwordx4 v39, s[28:31], s10 offen nt lds
  s_add_u32 m0, s11, 70656
  s_nop 0
  buffer_load_dwordx4 v40, s[28:31], s10 offen nt lds
  s_cmp_eq_u32 s3, 0
  s_cbranch_scc0 Ld9_48
  s_mov_b32 m0, 74752
  s_nop 0
  buffer_load_dwordx4 v41, s[28:31], s10 offen nt lds
Ld9_48:
  s_add_u32 s10, s15, 331776
  s_lshl_b32 s11, s3, 10
  s_add_u32 m0, s11, 75776
  s_nop 0
  buffer_load_dwordx4 v39, s[28:31], s10 offen nt lds
  s_add_u32 m0, s11, 79872
  s_nop 0
  buffer_load_dwordx4 v40, s[28:31], s10 offen nt lds
  s_cmp_eq_u32 s3, 0
  s_cbranch_scc0 Ld9_49
  s_mov_b32 m0, 83968
  s_nop 0
  buffer_load_dwordx4 v41, s[28:31], s10 offen nt lds
Ld9_49:
  s_add_u32 s10, s15, 479232
  s_lshl_b32 s11, s3, 10
  s_add_u32 m0, s11, 84992
  s_nop 0
  buffer_load_dwordx4 v39, s[28:31], s10 offen nt lds
  s_add_u32 m0, s11, 89088
  s_nop 0
  buffer_load_dwordx4 v40, s[28:31], s10 offen nt lds
  s_cmp_eq_u32 s3, 0
  s_cbranch_scc0 Ld9_50
  s_mov_b32 m0, 93184
  s_nop 0
  buffer_load_dwordx4 v41, s[28:31], s10 offen nt lds
Ld9_50:
  s_add_u32 s10, s15, 73728
  s_lshl_b32 s11, s3, 10
  s_add_u32 m0, s11, 94208
  s_nop 0
  buffer_load_dwordx4 v39, s[28:31], s10 offen nt lds
  s_add_u32 m0, s11, 98304
  s_nop 0
  buffer_load_dwordx4 v40, s[28:31], s10 offen nt lds
  s_cmp_eq_u32 s3, 0
  s_cbranch_scc0 Ld9_51
  s_mov_b32 m0, 102400
  s_nop 0
  buffer_load_dwordx4 v41, s[28:31], s10 offen nt lds
Ld9_51:
  s_add_u32 s10, s15, 221184
  s_lshl_b32 s11, s3, 10
  s_add_u32 m0, s11, 103424
  s_nop 0
  buffer_load_dwordx4 v39, s[28:31], s10 offen nt lds
  s_add_u32 m0, s11, 107520
  s_nop 0
  buffer_load_dwordx4 v40, s[28:31], s10 offen nt lds
  s_cmp_eq_u32 s3, 0
  s_cbranch_scc0 Ld9_52
  s_mov_b32 m0, 111616
  s_nop 0
  buffer_load_dwordx4 v41, s[28:31], s10 offen nt lds
Ld9_52:
  s_waitcnt vmcnt(20)
  s_barrier
  v_bfe_u32 v43, v0, 2, 2
  v_lshrrev_b32 v42, 4, v0
  v_lshl_add_u32 v42, v42, 3, v43
  v_lshlrev_b32 v44, 8, v42
  v_bfe_u32 v42, v0, 1, 1
  v_lshlrev_b32 v43, 1, v43
  s_lshl_b32 s10, s3, 2
  v_add_u32 v42, s10, v42
  v_xor_b32 v42, v42, v43
  v_lshl_add_u32 v44, v42, 4, v44
  v_and_b32 v42, 1, v0
  v_lshl_add_u32 v44, v42, 3, v44
  v_add_u32 v44, 0, v44
  v_xor_b32 v45, 32, v44
  v_xor_b32 v46, 128, v44
  v_xor_b32 v47, 160, v44
  ds_read_b64_tr_b16 v[12:13], v44 offset:0
  ds_read_b64_tr_b16 v[14:15], v46 offset:1024
  ds_read_b64_tr_b16 v[16:17], v45 offset:0
  ds_read_b64_tr_b16 v[18:19], v47 offset:1024
  ds_read_b64_tr_b16 v[20:21], v44 offset:8192
  ds_read_b64_tr_b16 v[22:23], v46 offset:9216
  ds_read_b64_tr_b16 v[24:25], v45 offset:8192
  ds_read_b64_tr_b16 v[26:27], v47 offset:9216
  ds_read_b64_tr_b16 v[28:29], v44 offset:16384
  ds_read_b64_tr_b16 v[30:31], v46 offset:17408
  ds_read_b64_tr_b16 v[32:33], v45 offset:16384
  ds_read_b64_tr_b16 v[34:35], v47 offset:17408
  s_waitcnt lgkmcnt(0)
  s_waitcnt lgkmcnt(0)
  s_barrier
  v_add_u32 v44, 0, v3
  ds_write_b128 v44, v[12:15] offset:0
  ds_write_b128 v44, v[16:19] offset:1024
  ds_write_b128 v44, v[20:23] offset:8192
  ds_write_b128 v44, v[24:27] offset:9216
  ds_write_b128 v44, v[28:31] offset:16384
  ds_write_b128 v44, v[32:35] offset:17408
  s_waitcnt lgkmcnt(0)
  v_bfe_u32 v43, v0, 2, 2
  v_lshrrev_b32 v42, 4, v0
  v_lshl_add_u32 v42, v42, 3, v43
  v_lshlrev_b32 v44, 8, v42
  v_bfe_u32 v42, v0, 1, 1
  v_lshlrev_b32 v43, 1, v43
  s_lshl_b32 s10, s3, 2
  v_add_u32 v42, s10, v42
  v_xor_b32 v42, v42, v43
  v_lshl_add_u32 v44, v42, 4, v44
  v_and_b32 v42, 1, v0
  v_lshl_add_u32 v44, v42, 3, v44
  v_add_u32 v44, 0, v44
  v_xor_b32 v45, 32, v44
  v_xor_b32 v46, 128, v44
  v_xor_b32 v47, 160, v44
  ds_read_b64_tr_b16 v[12:13], v44 offset:24576
  ds_read_b64_tr_b16 v[14:15], v46 offset:25600
  ds_read_b64_tr_b16 v[16:17], v45 offset:24576
  ds_read_b64_tr_b16 v[18:19], v47 offset:25600
  ds_read_b64_tr_b16 v[20:21], v44 offset:32768
  ds_read_b64_tr_b16 v[22:23], v46 offset:33792
  ds_read_b64_tr_b16 v[24:25], v45 offset:32768
  ds_read_b64_tr_b16 v[26:27], v47 offset:33792
  ds_read_b64_tr_b16 v[28:29], v44 offset:40960
  ds_read_b64_tr_b16 v[30:31], v46 offset:41984
  ds_read_b64_tr_b16 v[32:33], v45 offset:40960
  ds_read_b64_tr_b16 v[34:35], v47 offset:41984
  s_waitcnt lgkmcnt(0)
  ds_read_b64_tr_b16 v[36:37], v44 offset:49152
  ds_read_b64_tr_b16 v[38:39], v46 offset:50176
  ds_read_b64_tr_b16 v[40:41], v45 offset:49152
  ds_read_b64_tr_b16 v[42:43], v47 offset:50176
  s_waitcnt lgkmcnt(0)
  s_barrier
  v_add_u32 v44, 0, v3
  ds_write_b128 v44, v[12:15] offset:24576
  ds_write_b128 v44, v[16:19] offset:25600
  ds_write_b128 v44, v[20:23] offset:32768
  ds_write_b128 v44, v[24:27] offset:33792
  ds_write_b128 v44, v[28:31] offset:40960
  ds_write_b128 v44, v[32:35] offset:41984
  ds_write_b128 v44, v[36:39] offset:49152
  ds_write_b128 v44, v[40:43] offset:50176
  s_waitcnt lgkmcnt(0)
  s_barrier
  s_waitcnt vmcnt(18)
  s_barrier
  s_cmp_eq_u32 s3, 0
  s_cbranch_scc0 Lcb_53
  v_lshrrev_b32 v42, 4, v0
  v_bfe_u32 v43, v0, 2, 2
  v_lshl_add_u32 v42, v42, 3, v43
  v_mul_u32_u24 v44, 288, v42
  v_and_b32 v42, 3, v0
  v_lshl_add_u32 v44, v42, 3, v44
  v_add_u32 v44, 114688, v44
  ds_read_b64_tr_b16 v[136:137], v44 offset:0
  ds_read_b64_tr_b16 v[138:139], v44 offset:1152
  ds_read_b64_tr_b16 v[140:141], v44 offset:32
  ds_read_b64_tr_b16 v[142:143], v44 offset:1184
  ds_read_b64_tr_b16 v[144:145], v44 offset:64
  ds_read_b64_tr_b16 v[146:147], v44 offset:1216
  ds_read_b64_tr_b16 v[148:149], v44 offset:96
  ds_read_b64_tr_b16 v[150:151], v44 offset:1248
  ds_read_b64_tr_b16 v[152:153], v44 offset:128
  ds_read_b64_tr_b16 v[154:155], v44 offset:1280
  ds_read_b64_tr_b16 v[156:157], v44 offset:160
  ds_read_b64_tr_b16 v[158:159], v44 offset:1312
  s_waitcnt lgkmcnt(0)
  ds_read_b64_tr_b16 v[160:161], v44 offset:192
  ds_read_b64_tr_b16 v[162:163], v44 offset:1344
  ds_read_b64_tr_b16 v[164:165], v44 offset:224
  ds_read_b64_tr_b16 v[166:167], v44 offset:1376
  ds_read_b64_tr_b16 v[168:169], v44 offset:256
  ds_read_b64_tr_b16 v[170:171], v44 offset:1408
Lcb_53:
  s_waitcnt lgkmcnt(0)
  s_waitcnt vmcnt(16)
  s_barrier
  s_lshl_b32 s10, s3, 6
  v_add_u32 v42, s10, v0
  v_add_u32 v42, 0, v42
  v_mul_u32_u24 v39, 3641, v42
  v_lshrrev_b32 v39, 16, v39
  v_mul_u32_u24 v43, 18, v39
  v_sub_u32 v42, v42, v43
  v_mul_u32_u24 v39, 1152, v39
  v_lshl_add_u32 v39, v42, 4, v39
  s_lshl_b32 s10, s3, 6
  v_add_u32 v42, s10, v0
  v_add_u32 v42, 256, v42
  v_mul_u32_u24 v40, 3641, v42
  v_lshrrev_b32 v40, 16, v40
  v_mul_u32_u24 v43, 18, v40
  v_sub_u32 v42, v42, v43
  v_mul_u32_u24 v40, 1152, v40
  v_lshl_add_u32 v40, v42, 4, v40
  s_lshl_b32 s10, s3, 6
  v_add_u32 v42, s10, v0
  v_add_u32 v42, 512, v42
  v_mul_u32_u24 v41, 3641, v42
  v_lshrrev_b32 v41, 16, v41
  v_mul_u32_u24 v43, 18, v41
  v_sub_u32 v42, v42, v43
  v_mul_u32_u24 v41, 1152, v41
  v_lshl_add_u32 v41, v42, 4, v41
  s_mul_i32 s15, s5, 589824
  s_mul_i32 s10, s6, 288
  s_add_u32 s15, s15, s10
  s_add_u32 s10, s15, 368640
  s_lshl_b32 s11, s3, 10
  s_add_u32 m0, s11, 114688
  s_nop 0
  buffer_load_dwordx4 v39, s[28:31], s10 offen nt lds
  s_add_u32 m0, s11, 118784
  s_nop 0
  buffer_load_dwordx4 v40, s[28:31], s10 offen nt lds
  s_cmp_eq_u32 s3, 0
  s_cbranch_scc0 Ld9_54
  s_mov_b32 m0, 122880
  s_nop 0
  buffer_load_dwordx4 v41, s[28:31], s10 offen nt lds
Ld9_54:
  s_cmp_eq_u32 s3, 1
  s_cbranch_scc0 Lcb_55
  v_lshrrev_b32 v42, 4, v0
  v_bfe_u32 v43, v0, 2, 2
  v_lshl_add_u32 v42, v42, 3, v43
  v_mul_u32_u24 v44, 288, v42
  v_and_b32 v42, 3, v0
  v_lshl_add_u32 v44, v42, 3, v44
  v_add_u32 v44, 123904, v44
  ds_read_b64_tr_b16 v[136:137], v44 offset:0
  ds_read_b64_tr_b16 v[138:139], v44 offset:1152
  ds_read_b64_tr_b16 v[140:141], v44 offset:32
  ds_read_b64_tr_b16 v[142:143], v44 offset:1184
  ds_read_b64_tr_b16 v[144:145], v44 offset:64
  ds_read_b64_tr_b16 v[146:147], v44 offset:1216
  ds_read_b64_tr_b16 v[148:149], v44 offset:96
  ds_read_b64_tr_b16 v[150:151], v44 offset:1248
  ds_read_b64_tr_b16 v[152:153], v44 offset:128
  ds_read_b64_tr_b16 v[154:155], v44 offset:1280
  ds_read_b64_tr_b16 v[156:157], v44 offset:160
  ds_read_b64_tr_b16 v[158:159], v44 offset:1312
  s_waitcnt lgkmcnt(0)
  ds_read_b64_tr_b16 v[160:161], v44 offset:192
  ds_read_b64_tr_b16 v[162:163], v44 offset:1344
  ds_read_b64_tr_b16 v[164:165], v44 offset:224
  ds_read_b64_tr_b16 v[166:167], v44 offset:1376
  ds_read_b64_tr_b16 v[168:169], v44 offset:256
  ds_read_b64_tr_b16 v[170:171], v44 offset:1408
Lcb_55:
  s_waitcnt lgkmcnt(0)
  s_waitcnt vmcnt(16)
  s_barrier
  s_add_u32 s10, s15, 516096
  s_lshl_b32 s11, s3, 10
  s_add_u32 m0, s11, 123904
  s_nop 0
  buffer_load_dwordx4 v39, s[28:31], s10 offen nt lds
  s_add_u32 m0, s11, 128000
  s_nop 0
  buffer_load_dwordx4 v40, s[28:31], s10 offen nt lds
  s_cmp_eq_u32 s3, 0
  s_cbranch_scc0 Ld9_56
  s_mov_b32 m0, 132096
  s_nop 0
  buffer_load_dwordx4 v41, s[28:31], s10 offen nt lds
Ld9_56:
  s_cmp_eq_u32 s3, 2
  s_cbranch_scc0 Lcb_57
  v_lshrrev_b32 v42, 4, v0
  v_bfe_u32 v43, v0, 2, 2
  v_lshl_add_u32 v42, v42, 3, v43
  v_mul_u32_u24 v44, 288, v42
  v_and_b32 v42, 3, v0
  v_lshl_add_u32 v44, v42, 3, v44
  v_add_u32 v44, 133120, v44
  ds_read_b64_tr_b16 v[136:137], v44 offset:0
  ds_read_b64_tr_b16 v[138:139], v44 offset:1152
  ds_read_b64_tr_b16 v[140:141], v44 offset:32
  ds_read_b64_tr_b16 v[142:143], v44 offset:1184
  ds_read_b64_tr_b16 v[144:145], v44 offset:64
  ds_read_b64_tr_b16 v[146:147], v44 offset:1216
  ds_read_b64_tr_b16 v[148:149], v44 offset:96
  ds_read_b64_tr_b16 v[150:151], v44 offset:1248
  ds_read_b64_tr_b16 v[152:153], v44 offset:128
  ds_read_b64_tr_b16 v[154:155], v44 offset:1280
  ds_read_b64_tr_b16 v[156:157], v44 offset:160
  ds_read_b64_tr_b16 v[158:159], v44 offset:1312
  s_waitcnt lgkmcnt(0)
  ds_read_b64_tr_b16 v[160:161], v44 offset:192
  ds_read_b64_tr_b16 v[162:163], v44 offset:1344
  ds_read_b64_tr_b16 v[164:165], v44 offset:224
  ds_read_b64_tr_b16 v[166:167], v44 offset:1376
  ds_read_b64_tr_b16 v[168:169], v44 offset:256
  ds_read_b64_tr_b16 v[170:171], v44 offset:1408
Lcb_57:
  s_waitcnt lgkmcnt(0)
  s_waitcnt vmcnt(16)
  s_barrier
  s_add_u32 s10, s15, 110592
  s_lshl_b32 s11, s3, 10
  s_add_u32 m0, s11, 133120
  s_nop 0
  buffer_load_dwordx4 v39, s[28:31], s10 offen nt lds
  s_add_u32 m0, s11, 137216
  s_nop 0
  buffer_load_dwordx4 v40, s[28:31], s10 offen nt lds
  s_cmp_eq_u32 s3, 0
  s_cbranch_scc0 Ld9_58
  s_mov_b32 m0, 141312
  s_nop 0
  buffer_load_dwordx4 v41, s[28:31], s10 offen nt lds
Ld9_58:
  s_cmp_eq_u32 s3, 3
  s_cbranch_scc0 Lcb_59
  v_lshrrev_b32 v42, 4, v0
  v_bfe_u32 v43, v0, 2, 2
  v_lshl_add_u32 v42, v42, 3, v43
  v_mul_u32_u24 v44, 288, v42
  v_and_b32 v42, 3, v0
  v_lshl_add_u32 v44, v42, 3, v44
  v_add_u32 v44, 142336, v44
  ds_read_b64_tr_b16 v[136:137], v44 offset:0
  ds_read_b64_tr_b16 v[138:139], v44 offset:1152
  ds_read_b64_tr_b16 v[140:141], v44 offset:32
  ds_read_b64_tr_b16 v[142:143], v44 offset:1184
  ds_read_b64_tr_b16 v[144:145], v44 offset:64
  ds_read_b64_tr_b16 v[146:147], v44 offset:1216
  ds_read_b64_tr_b16 v[148:149], v44 offset:96
  ds_read_b64_tr_b16 v[150:151], v44 offset:1248
  ds_read_b64_tr_b16 v[152:153], v44 offset:128
  ds_read_b64_tr_b16 v[154:155], v44 offset:1280
  ds_read_b64_tr_b16 v[156:157], v44 offset:160
  ds_read_b64_tr_b16 v[158:159], v44 offset:1312
  s_waitcnt lgkmcnt(0)
  ds_read_b64_tr_b16 v[160:161], v44 offset:192
  ds_read_b64_tr_b16 v[162:163], v44 offset:1344
  ds_read_b64_tr_b16 v[164:165], v44 offset:224
  ds_read_b64_tr_b16 v[166:167], v44 offset:1376
  ds_read_b64_tr_b16 v[168:169], v44 offset:256
  ds_read_b64_tr_b16 v[170:171], v44 offset:1408
Lcb_59:
  s_waitcnt lgkmcnt(0)
  ds_read_b128 v[36:39], v3 offset:0
  ds_read_b128 v[40:43], v3 offset:1024
  ds_read_b128 v[44:47], v3 offset:8192
  ds_read_b128 v[20:23], v2 offset:0
  ds_read_b128 v[24:27], v2 offset:704
  ds_read_b128 v[28:31], v2 offset:64
  ds_read_b128 v[32:35], v2 offset:768
  s_waitcnt lgkmcnt(3)
  v_mfma_f32_16x16x32_bf16 v[12:15], v[20:23], v[48:51], 0
  v_mfma_f32_16x16x32_bf16 v[16:19], v[20:23], v[52:55], 0
  ds_read_b128 v[20:23], v2 offset:128
  s_waitcnt lgkmcnt(3)
  v_mfma_f32_16x16x32_bf16 v[12:15], v[24:27], v[36:39], v[12:15]
  ds_read_b128 v[36:39], v3 offset:9216
  v_mfma_f32_16x16x32_bf16 v[16:19], v[24:27], v[40:43], v[16:19]
  ds_read_b128 v[40:43], v3 offset:16384
  ds_read_b128 v[24:27], v2 offset:832
  s_waitcnt lgkmcnt(5)
  v_mfma_f32_16x16x32_bf16 v[12:15], v[28:31], v[56:59], v[12:15]
  v_mfma_f32_16x16x32_bf16 v[16:19], v[28:31], v[60:63], v[16:19]
  ds_read_b128 v[28:31], v2 offset:192
  s_waitcnt lgkmcnt(5)
  v_mfma_f32_16x16x32_bf16 v[12:15], v[32:35], v[44:47], v[12:15]
  ds_read_b128 v[44:47], v3 offset:17408
  s_waitcnt lgkmcnt(4)
  v_mfma_f32_16x16x32_bf16 v[16:19], v[32:35], v[36:39], v[16:19]
  ds_read_b128 v[36:39], v3 offset:24576
  ds_read_b128 v[32:35], v2 offset:896
  v_mfma_f32_16x16x32_bf16 v[12:15], v[20:23], v[64:67], v[12:15]
  v_mfma_f32_16x16x32_bf16 v[16:19], v[20:23], v[68:71], v[16:19]
  ds_read_b128 v[20:23], v2 offset:256
  s_waitcnt lgkmcnt(5)
  v_mfma_f32_16x16x32_bf16 v[12:15], v[24:27], v[40:43], v[12:15]
  ds_read_b128 v[40:43], v3 offset:25600
  s_waitcnt lgkmcnt(4)
  v_mfma_f32_16x16x32_bf16 v[16:19], v[24:27], v[44:47], v[16:19]
  ds_read_b128 v[44:47], v3 offset:32768
  ds_read_b128 v[24:27], v2 offset:960
  v_mfma_f32_16x16x32_bf16 v[12:15], v[28:31], v[72:75], v[12:15]
  v_mfma_f32_16x16x32_bf16 v[16:19], v[28:31], v[76:79], v[16:19]
  ds_read_b128 v[28:31], v2 offset:320
  s_waitcnt lgkmcnt(5)
  v_mfma_f32_16x16x32_bf16 v[12:15], v[32:35], v[36:39], v[12:15]
  ds_read_b128 v[36:39], v3 offset:33792
  s_waitcnt lgkmcnt(4)
  v_mfma_f32_16x16x32_bf16 v[16:19], v[32:35], v[40:43], v[16:19]
  ds_read_b128 v[40:43], v3 offset:40960
  ds_read_b128 v[32:35], v2 offset:1024
  v_mfma_f32_16x16x32_bf16 v[12:15], v[20:23], v[80:83], v[12:15]
  v_mfma_f32_16x16x32_bf16 v[16:19], v[20:23], v[84:87], v[16:19]
  ds_read_b128 v[20:23], v2 offset:384
  s_waitcnt lgkmcnt(5)
  v_mfma_f32_16x16x32_bf16 v[12:15], v[24:27], v[44:47], v[12:15]
  ds_read_b128 v[44:47], v3 offset:41984
  s_waitcnt lgkmcnt(4)
  v_mfma_f32_16x16x32_bf16 v[16:19], v[24:27], v[36:39], v[16:19]
  ds_read_b128 v[36:39], v3 offset:49152
  ds_read_b128 v[24:27], v2 offset:1088
  v_mfma_f32_16x16x32_bf16 v[12:15], v[28:31], v[88:91], v[12:15]
  v_mfma_f32_16x16x32_bf16 v[16:19], v[28:31], v[92:95], v[16:19]
  ds_read_b128 v[28:31], v2 offset:448
  s_waitcnt lgkmcnt(5)
  v_mfma_f32_16x16x32_bf16 v[12:15], v[32:35], v[40:43], v[12:15]
  ds_read_b128 v[40:43], v3 offset:50176
  s_waitcnt lgkmcnt(4)
  v_mfma_f32_16x16x32_bf16 v[16:19], v[32:35], v[44:47], v[16:19]
  ds_read_b128 v[32:35], v2 offset:512
  v_mfma_f32_16x16x32_bf16 v[12:15], v[20:23], v[96:99], v[12:15]
  v_mfma_f32_16x16x32_bf16 v[16:19], v[20:23], v[100:103], v[16:19]
  ds_read_b128 v[20:23], v2 offset:576
  s_waitcnt lgkmcnt(4)
  v_mfma_f32_16x16x32_bf16 v[12:15], v[24:27], v[36:39], v[12:15]
  s_waitcnt lgkmcnt(2)
  v_mfma_f32_16x16x32_bf16 v[16:19], v[24:27], v[40:43], v[16:19]
  ds_read_b128 v[24:27], v2 offset:640
  v_mfma_f32_16x16x32_bf16 v[12:15], v[28:31], v[104:107], v[12:15]
  v_mfma_f32_16x16x32_bf16 v[16:19], v[28:31], v[108:111], v[16:19]
  s_waitcnt lgkmcnt(2)
  v_mfma_f32_16x16x32_bf16 v[12:15], v[32:35], v[112:115], v[12:15]
  v_mfma_f32_16x16x32_bf16 v[16:19], v[32:35], v[116:119], v[16:19]
  s_waitcnt lgkmcnt(1)
  v_mfma_f32_16x16x32_bf16 v[12:15], v[20:23], v[120:123], v[12:15]
  v_mfma_f32_16x16x32_bf16 v[16:19], v[20:23], v[124:127], v[16:19]
  s_waitcnt lgkmcnt(0)
  v_mfma_f32_16x16x32_bf16 v[12:15], v[24:27], v[128:131], v[12:15]
  v_mfma_f32_16x16x32_bf16 v[16:19], v[24:27], v[132:135], v[16:19]
  s_nop 6
  v_mov_b32 v11, v12
  v_cndmask_b32 v11, v11, v16, s[60:61]
  s_waitcnt vmcnt(16)
  s_barrier
  s_lshl_b32 s10, s3, 6
  v_add_u32 v42, s10, v0
  v_add_u32 v42, 0, v42
  v_mul_u32_u24 v39, 3641, v42
  v_lshrrev_b32 v39, 16, v39
  v_mul_u32_u24 v43, 18, v39
  v_sub_u32 v42, v42, v43
  v_mul_u32_u24 v39, 1152, v39
  v_lshl_add_u32 v39, v42, 4, v39
  s_lshl_b32 s10, s3, 6
  v_add_u32 v42, s10, v0
  v_add_u32 v42, 256, v42
  v_mul_u32_u24 v40, 3641, v42
  v_lshrrev_b32 v40, 16, v40
  v_mul_u32_u24 v43, 18, v40
  v_sub_u32 v42, v42, v43
  v_mul_u32_u24 v40, 1152, v40
  v_lshl_add_u32 v40, v42, 4, v40
  s_lshl_b32 s10, s3, 6
  v_add_u32 v42, s10, v0
  v_add_u32 v42, 512, v42
  v_mul_u32_u24 v41, 3641, v42
  v_lshrrev_b32 v41, 16, v41
  v_mul_u32_u24 v43, 18, v41
  v_sub_u32 v42, v42, v43
  v_mul_u32_u24 v41, 1152, v41
  v_lshl_add_u32 v41, v42, 4, v41
  s_mul_i32 s15, s5, 589824
  s_mul_i32 s10, s6, 288
  s_add_u32 s15, s15, s10
  s_add_u32 s10, s15, 258048
  s_lshl_b32 s11, s3, 10
  s_add_u32 m0, s11, 142336
  s_nop 0
  buffer_load_dwordx4 v39, s[28:31], s10 offen nt lds
  s_add_u32 m0, s11, 146432
  s_nop 0
  buffer_load_dwordx4 v40, s[28:31], s10 offen nt lds
  s_cmp_eq_u32 s3, 0
  s_cbranch_scc0 Ld9_60
  s_mov_b32 m0, 150528
  s_nop 0
  buffer_load_dwordx4 v41, s[28:31], s10 offen nt lds
Ld9_60:
  s_cmp_eq_u32 s3, 0
  s_cbranch_scc0 Lcb_61
  v_lshrrev_b32 v42, 4, v0
  v_bfe_u32 v43, v0, 2, 2
  v_lshl_add_u32 v42, v42, 3, v43
  v_mul_u32_u24 v44, 288, v42
  v_and_b32 v42, 3, v0
  v_lshl_add_u32 v44, v42, 3, v44
  v_add_u32 v44, 57344, v44
  ds_read_b64_tr_b16 v[172:173], v44 offset:0
  ds_read_b64_tr_b16 v[174:175], v44 offset:1152
  ds_read_b64_tr_b16 v[176:177], v44 offset:32
  ds_read_b64_tr_b16 v[178:179], v44 offset:1184
  ds_read_b64_tr_b16 v[180:181], v44 offset:64
  ds_read_b64_tr_b16 v[182:183], v44 offset:1216
  ds_read_b64_tr_b16 v[184:185], v44 offset:96
  ds_read_b64_tr_b16 v[186:187], v44 offset:1248
  ds_read_b64_tr_b16 v[188:189], v44 offset:128
  ds_read_b64_tr_b16 v[190:191], v44 offset:1280
  ds_read_b64_tr_b16 v[192:193], v44 offset:160
  ds_read_b64_tr_b16 v[194:195], v44 offset:1312
  s_waitcnt lgkmcnt(0)
  ds_read_b64_tr_b16 v[196:197], v44 offset:192
  ds_read_b64_tr_b16 v[198:199], v44 offset:1344
  ds_read_b64_tr_b16 v[200:201], v44 offset:224
  ds_read_b64_tr_b16 v[202:203], v44 offset:1376
  ds_read_b64_tr_b16 v[204:205], v44 offset:256
  ds_read_b64_tr_b16 v[206:207], v44 offset:1408
Lcb_61:
  s_waitcnt lgkmcnt(0)
  s_waitcnt vmcnt(16)
  s_barrier
  s_add_u32 s10, s15, 405504
  s_lshl_b32 s11, s3, 10
  s_add_u32 m0, s11, 57344
  s_nop 0
  buffer_load_dwordx4 v39, s[28:31], s10 offen nt lds
  s_add_u32 m0, s11, 61440
  s_nop 0
  buffer_load_dwordx4 v40, s[28:31], s10 offen nt lds
  s_cmp_eq_u32 s3, 0
  s_cbranch_scc0 Ld9_62
  s_mov_b32 m0, 65536
  s_nop 0
  buffer_load_dwordx4 v41, s[28:31], s10 offen nt lds
Ld9_62:
  s_cmp_eq_u32 s3, 1
  s_cbranch_scc0 Lcb_63
  v_lshrrev_b32 v42, 4, v0
  v_bfe_u32 v43, v0, 2, 2
  v_lshl_add_u32 v42, v42, 3, v43
  v_mul_u32_u24 v44, 288, v42
  v_and_b32 v42, 3, v0
  v_lshl_add_u32 v44, v42, 3, v44
  v_add_u32 v44, 66560, v44
  ds_read_b64_tr_b16 v[172:173], v44 offset:0
  ds_read_b64_tr_b16 v[174:175], v44 offset:1152
  ds_read_b64_tr_b16 v[176:177], v44 offset:32
  ds_read_b64_tr_b16 v[178:179], v44 offset:1184
  ds_read_b64_tr_b16 v[180:181], v44 offset:64
  ds_read_b64_tr_b16 v[182:183], v44 offset:1216
  ds_read_b64_tr_b16 v[184:185], v44 offset:96
  ds_read_b64_tr_b16 v[186:187], v44 offset:1248
  ds_read_b64_tr_b16 v[188:189], v44 offset:128
  ds_read_b64_tr_b16 v[190:191], v44 offset:1280
  ds_read_b64_tr_b16 v[192:193], v44 offset:160
  ds_read_b64_tr_b16 v[194:195], v44 offset:1312
  s_waitcnt lgkmcnt(0)
  ds_read_b64_tr_b16 v[196:197], v44 offset:192
  ds_read_b64_tr_b16 v[198:199], v44 offset:1344
  ds_read_b64_tr_b16 v[200:201], v44 offset:224
  ds_read_b64_tr_b16 v[202:203], v44 offset:1376
  ds_read_b64_tr_b16 v[204:205], v44 offset:256
  ds_read_b64_tr_b16 v[206:207], v44 offset:1408
Lcb_63:
  s_waitcnt lgkmcnt(0)
  s_waitcnt vmcnt(16)
  s_barrier
  s_add_u32 s10, s15, 552960
  s_lshl_b32 s11, s3, 10
  s_add_u32 m0, s11, 66560
  s_nop 0
  buffer_load_dwordx4 v39, s[28:31], s10 offen nt lds
  s_add_u32 m0, s11, 70656
  s_nop 0
  buffer_load_dwordx4 v40, s[28:31], s10 offen nt lds
  s_cmp_eq_u32 s3, 0
  s_cbranch_scc0 Ld9_64
  s_mov_b32 m0, 74752
  s_nop 0
  buffer_load_dwordx4 v41, s[28:31], s10 offen nt lds
Ld9_64:
  s_cmp_eq_u32 s3, 2
  s_cbranch_scc0 Lcb_65
  v_lshrrev_b32 v42, 4, v0
  v_bfe_u32 v43, v0, 2, 2
  v_lshl_add_u32 v42, v42, 3, v43
  v_mul_u32_u24 v44, 288, v42
  v_and_b32 v42, 3, v0
  v_lshl_add_u32 v44, v42, 3, v44
  v_add_u32 v44, 75776, v44
  ds_read_b64_tr_b16 v[172:173], v44 offset:0
  ds_read_b64_tr_b16 v[174:175], v44 offset:1152
  ds_read_b64_tr_b16 v[176:177], v44 offset:32
  ds_read_b64_tr_b16 v[178:179], v44 offset:1184
  ds_read_b64_tr_b16 v[180:181], v44 offset:64
  ds_read_b64_tr_b16 v[182:183], v44 offset:1216
  ds_read_b64_tr_b16 v[184:185], v44 offset:96
  ds_read_b64_tr_b16 v[186:187], v44 offset:1248
  ds_read_b64_tr_b16 v[188:189], v44 offset:128
  ds_read_b64_tr_b16 v[190:191], v44 offset:1280
  ds_read_b64_tr_b16 v[192:193], v44 offset:160
  ds_read_b64_tr_b16 v[194:195], v44 offset:1312
  s_waitcnt lgkmcnt(0)
  ds_read_b64_tr_b16 v[196:197], v44 offset:192
  ds_read_b64_tr_b16 v[198:199], v44 offset:1344
  ds_read_b64_tr_b16 v[200:201], v44 offset:224
  ds_read_b64_tr_b16 v[202:203], v44 offset:1376
  ds_read_b64_tr_b16 v[204:205], v44 offset:256
  ds_read_b64_tr_b16 v[206:207], v44 offset:1408
Lcb_65:
  s_waitcnt lgkmcnt(0)
  s_waitcnt vmcnt(16)
  s_barrier
  s_lshl_b32 s10, s3, 6
  v_add_u32 v42, s10, v0
  v_add_u32 v42, 0, v42
  v_mul_u32_u24 v39, 3641, v42
  v_lshrrev_b32 v39, 16, v39
  v_mul_u32_u24 v43, 18, v39
  v_sub_u32 v42, v42, v43
  v_mul_u32_u24 v39, 9216, v39
  v_lshl_add_u32 v39, v42, 4, v39
  s_lshl_b32 s10, s3, 6
  v_add_u32 v42, s10, v0
  v_add_u32 v42, 256, v42
  v_mul_u32_u24 v40, 3641, v42
  v_lshrrev_b32 v40, 16, v40
  v_mul_u32_u24 v43, 18, v40
  v_sub_u32 v42, v42, v43
  v_mul_u32_u24 v40, 9216, v40
  v_lshl_add_u32 v40, v42, 4, v40
  s_lshl_b32 s10, s3, 6
  v_add_u32 v42, s10, v0
  v_add_u32 v42, 512, v42
  v_mul_u32_u24 v41, 3641, v42
  v_lshrrev_b32 v41, 16, v41
  v_mul_u32_u24 v43, 18, v41
  v_sub_u32 v42, v42, v43
  v_mul_u32_u24 v41, 9216, v41
  v_lshl_add_u32 v41, v42, 4, v41
  s_mul_i32 s15, s4, 288
  s_add_u32 s10, s15, 0
  s_lshl_b32 s11, s3, 10
  s_add_u32 m0, s11, 75776
  s_nop 0
  buffer_load_dwordx4 v39, s[32:35], s10 offen nt lds
  s_add_u32 m0, s11, 79872
  s_nop 0
  buffer_load_dwordx4 v40, s[32:35], s10 offen nt lds
  s_cmp_eq_u32 s3, 0
  s_cbranch_scc0 Ld9_66
  s_mov_b32 m0, 83968
  s_nop 0
  buffer_load_dwordx4 v41, s[32:35], s10 offen nt lds
Ld9_66:
  s_cmp_eq_u32 s3, 3
  s_cbranch_scc0 Lcb_67
  v_lshrrev_b32 v42, 4, v0
  v_bfe_u32 v43, v0, 2, 2
  v_lshl_add_u32 v42, v42, 3, v43
  v_mul_u32_u24 v44, 288, v42
  v_and_b32 v42, 3, v0
  v_lshl_add_u32 v44, v42, 3, v44
  v_add_u32 v44, 84992, v44
  ds_read_b64_tr_b16 v[172:173], v44 offset:0
  ds_read_b64_tr_b16 v[174:175], v44 offset:1152
  ds_read_b64_tr_b16 v[176:177], v44 offset:32
  ds_read_b64_tr_b16 v[178:179], v44 offset:1184
  ds_read_b64_tr_b16 v[180:181], v44 offset:64
  ds_read_b64_tr_b16 v[182:183], v44 offset:1216
  ds_read_b64_tr_b16 v[184:185], v44 offset:96
  ds_read_b64_tr_b16 v[186:187], v44 offset:1248
  ds_read_b64_tr_b16 v[188:189], v44 offset:128
  ds_read_b64_tr_b16 v[190:191], v44 offset:1280
  ds_read_b64_tr_b16 v[192:193], v44 offset:160
  ds_read_b64_tr_b16 v[194:195], v44 offset:1312
  s_waitcnt lgkmcnt(0)
  ds_read_b64_tr_b16 v[196:197], v44 offset:192
  ds_read_b64_tr_b16 v[198:199], v44 offset:1344
  ds_read_b64_tr_b16 v[200:201], v44 offset:224
  ds_read_b64_tr_b16 v[202:203], v44 offset:1376
  ds_read_b64_tr_b16 v[204:205], v44 offset:256
  ds_read_b64_tr_b16 v[206:207], v44 offset:1408
Lcb_67:
  s_waitcnt lgkmcnt(0)
  s_mov_b32 s7, 0
  s_barrier
  s_branch L_q1
L_citer:
  s_sub_u32 s8, s7, 2
  s_bitcmp1_b32 s8, 0
  s_cbranch_scc1 Lx_68
  s_mul_i32 s10, s8, 576
  v_lshrrev_b32 v14, 1, v1
  s_add_u32 s10, s10, 157696
  v_add_u32 v14, s10, v14
  ds_read_b64 v[12:13], v14
  s_waitcnt lgkmcnt(0)
  v_lshlrev_b32 v5, 16, v12
  v_and_b32 v6, 0xffff0000, v12
  v_lshlrev_b32 v7, 16, v13
  v_and_b32 v8, 0xffff0000, v13
Lx_68:
  s_cmp_eq_u32 s3, 1
  s_cbranch_scc0 Lpt_69
  s_mul_i32 s10, s8, 18432
  s_add_u32 s10, s10, 688128
  v_add_u32 v46, 0, v0
  v_min_u32 v46, 143, v46
  v_lshlrev_b32 v46, 7, v46
  buffer_load_dword v47, v46, s[16:19], s10 offen sc1
  v_add_u32 v46, 64, v0
  v_min_u32 v46, 143, v46
  v_lshlrev_b32 v46, 7, v46
  buffer_load_dword v47, v46, s[16:19], s10 offen sc1
  v_add_u32 v46, 128, v0
  v_min_u32 v46, 143, v46
  v_lshlrev_b32 v46, 7, v46
  buffer_load_dword v47, v46, s[16:19], s10 offen sc1
  s_mul_i32 s10, s8, 18432
  s_add_u32 s10, s10, 798720
  v_add_u32 v46, 0, v0
  v_min_u32 v46, 143, v46
  v_lshlrev_b32 v46, 7, v46
  buffer_load_dword v47, v46, s[16:19], s10 offen sc1
  v_add_u32 v46, 64, v0
  v_min_u32 v46, 143, v46
  v_lshlrev_b32 v46, 7, v46
  buffer_load_dword v47, v46, s[16:19], s10 offen sc1
  v_add_u32 v46, 128, v0
  v_min_u32 v46, 143, v46
  v_lshlrev_b32 v46, 7, v46
  buffer_load_dword v47, v46, s[16:19], s10 offen sc1
  s_mul_i32 s10, s8, 9216
  s_add_u32 s10, s10, 761856
  v_add_u32 v46, 0, v0
  v_min_u32 v46, 71, v46
  v_lshlrev_b32 v46, 7, v46
  buffer_load_dword v47, v46, s[16:19], s10 offen sc1
  v_add_u32 v46, 64, v0
  v_min_u32 v46, 71, v46
  v_lshlrev_b32 v46, 7, v46
  buffer_load_dword v47, v46, s[16:19], s10 offen sc1
Lpt_69:
  s_lshl_b32 s11, s5, 2
  s_add_u32 s11, s11, s3
  s_mul_i32 s11, s11, 5120
  s_mul_i32 s12, s8, 163840
  s_add_u32 s11, s11, s12
  v_lshrrev_b32 v30, 5, v0
  v_mul_u32_u24 v30, 640, v30
  v_and_b32 v31, 31, v0
  v_lshlrev_b32 v32, 4, v31
  v_add_u32 v30, v32, v30
  v_and_b32 v31, 7, v0
  v_min_u32 v31, 6, v31
  v_mul_u32_u24 v31, 640, v31
  v_add_u32 v31, 512, v31
  s_mov_b32 s13, 0
Lpl_70:
  buffer_load_dwordx2 v[28:29], v31, s[16:19], s11 offen sc1
  buffer_load_dwordx4 v[12:15], v30, s[16:19], s11 offen offset:0 sc1
  buffer_load_dwordx4 v[16:19], v30, s[16:19], s11 offen offset:1280 sc1
  buffer_load_dwordx4 v[20:23], v30, s[16:19], s11 offen offset:2560 sc1
  buffer_load_dwordx4 v[24:27], v32, s[16:19], s11 offen offset:3840 sc1
  s_waitcnt vmcnt(0)
  v_max3_u32 v33, v12, v13, v14
  v_max3_u32 v33, v33, v15, v16
  v_max3_u32 v33, v33, v17, v18
  v_max3_u32 v33, v33, v19, v20
  v_max3_u32 v33, v33, v21, v22
  v_max3_u32 v33, v33, v23, v24
  v_max3_u32 v33, v33, v25, v26
  v_max3_u32 v33, v33, v27, v28
  v_max_u32 v33, v33, v29
  v_cmp_eq_u32 vcc, -1, v33
  s_nop 3
  s_cbranch_vccz Lpk_71
  s_add_u32 s13, s13, 1
  s_cmp_lt_u32 s13, 20000
  s_cbranch_scc1 Lpl_70
Lpk_71:
  s_and_b32 s10, s8, 1
  s_or_b32 s10, s10, s4
  s_or_b32 s10, s10, s3
  s_cmp_eq_u32 s10, 0
  s_cbranch_scc0 Lflag_72
  v_mov_b32 v33, 1
  s_lshl_b32 s10, s8, 1
  s_add_u32 s10, s10, 872448
  v_mov_b32 v34, s10
  s_mov_b64 exec, 1
  buffer_store_dword v33, v34, s[16:19], 0 offen sc0 sc1
  s_mov_b64 exec, -1
Lflag_72:
  v_mov_b32 v33, v28
  s_nop 1
  v_max_f32_dpp v33, v33, v33 row_ror:4 row_mask:0xf bank_mask:0xf
  s_nop 1
  v_max_f32_dpp v33, v33, v33 row_ror:2 row_mask:0xf bank_mask:0xf
  s_nop 1
  v_max_f32_dpp v33, v33, v33 row_ror:1 row_mask:0xf bank_mask:0xf
  v_sub_f32 v34, v28, v33
  v_exp_f32 v34, v34
  v_and_b32 v35, 7, v0
  v_cmp_eq_u32 vcc, 7, v35
  v_mov_b32 v35, 0
  s_nop 0
  v_cndmask_b32 v34, v34, v35, vcc
  v_mul_f32 v35, v34, v29
  s_nop 1
  v_add_f32_dpp v35, v35, v35 row_ror:4 row_mask:0xf bank_mask:0xf
  s_nop 1
  v_add_f32_dpp v35, v35, v35 row_ror:2 row_mask:0xf bank_mask:0xf
  s_nop 1
  v_add_f32_dpp v35, v35, v35 row_ror:1 row_mask:0xf bank_mask:0xf
  v_rcp_f32 v35, v35
  s_nop 0
  v_mul_f32 v34, v34, v35
  s_nop 0
  v_readlane_b32 s70, v34, 0
  v_readlane_b32 s71, v34, 1
  v_readlane_b32 s72, v34, 2
  v_readlane_b32 s73, v34, 3
  v_readlane_b32 s74, v34, 4
  v_readlane_b32 s75, v34, 5
  v_readlane_b32 s76, v34, 6
  v_mov_b32 v36, s70
  v_mov_b32 v37, s72
  v_mov_b32 v38, s74
  v_mov_b32 v39, s76
  v_mov_b32 v33, s71
  v_cndmask_b32 v36, v36, v33, s[66:67]
  v_mov_b32 v33, s73
  v_cndmask_b32 v37, v37, v33, s[66:67]
  v_mov_b32 v33, s75
  v_cndmask_b32 v38, v38, v33, s[66:67]
  v_mov_b32 v33, 0
  v_cndmask_b32 v39, v39, v33, s[66:67]
  v_mul_f32 v12, v12, v36
  v_mul_f32 v13, v13, v36
  v_mul_f32 v14, v14, v36
  v_mul_f32 v15, v15, v36
  v_fmac_f32 v12, v16, v37
  v_fmac_f32 v13, v17, v37
  v_fmac_f32 v14, v18, v37
  v_fmac_f32 v15, v19, v37
  v_fmac_f32 v12, v20, v38
  v_fmac_f32 v13, v21, v38
  v_fmac_f32 v14, v22, v38
  v_fmac_f32 v15, v23, v38
  v_fmac_f32 v12, v24, v39
  v_fmac_f32 v13, v25, v39
  v_fmac_f32 v14, v26, v39
  v_fmac_f32 v15, v27, v39
  v_mov_b32 v16, v12
  v_mov_b32 v17, v13
  v_mov_b32 v18, v14
  v_mov_b32 v19, v15
  v_permlane32_swap_b32 v12, v16
  v_permlane32_swap_b32 v13, v17
  v_permlane32_swap_b32 v14, v18
  v_permlane32_swap_b32 v15, v19
  v_add_f32 v12, v12, v16
  v_add_f32 v13, v13, v17
  v_add_f32 v14, v14, v18
  v_add_f32 v15, v15, v19
  v_cvt_pk_bf16_f32 v20, v12, v13
  v_cvt_pk_bf16_f32 v21, v14, v15
  v_and_b32 v33, 31, v0
  s_lshl_b32 s10, s3, 8
  s_add_u32 s10, s10, 154112
  v_lshl_add_u32 v33, v33, 3, s10
  s_mov_b32 exec_lo, -1
  s_mov_b32 exec_hi, 0
  ds_write_b64 v33, v[20:21]
  s_mov_b64 exec, -1
  s_sub_u32 s10, s10, 151552
  v_add_u32 v33, s10, v2
  s_waitcnt lgkmcnt(0)
  ds_read_b128 v[12:15], v33 offset:0
  ds_read_b128 v[16:19], v33 offset:64
  ds_read_b128 v[20:23], v33 offset:128
  ds_read_b128 v[24:27], v33 offset:192
  s_waitcnt lgkmcnt(3)
  v_mfma_f32_16x16x32_bf16 v[28:31], v[12:15], v[136:139], 0
  v_mfma_f32_16x16x32_bf16 v[32:35], v[12:15], v[140:143], 0
  v_mfma_f32_16x16x32_bf16 v[36:39], v[12:15], v[144:147], 0
  s_waitcnt lgkmcnt(2)
  v_mfma_f32_16x16x32_bf16 v[28:31], v[16:19], v[172:175], v[28:31]
  v_mfma_f32_16x16x32_bf16 v[32:35], v[16:19], v[176:179], v[32:35]
  v_mfma_f32_16x16x32_bf16 v[36:39], v[16:19], v[180:183], v[36:39]
  s_waitcnt lgkmcnt(1)
  v_mfma_f32_16x16x32_bf16 v[28:31], v[20:23], v[208:211], v[28:31]
  v_mfma_f32_16x16x32_bf16 v[32:35], v[20:23], v[212:215], v[32:35]
  v_mfma_f32_16x16x32_bf16 v[36:39], v[20:23], v[216:219], v[36:39]
  s_waitcnt lgkmcnt(0)
  v_mfma_f32_16x16x32_bf16 v[28:31], v[24:27], v[244:247], v[28:31]
  v_mfma_f32_16x16x32_bf16 v[32:35], v[24:27], v[248:251], v[32:35]
  v_mfma_f32_16x16x32_bf16 v[36:39], v[24:27], v[252:255], v[36:39]
  s_nop 5
  v_mov_b32 v40, v28
  v_cndmask_b32 v40, v40, v32, s[60:61]
  v_cndmask_b32 v40, v40, v36, s[62:63]
  v_mfma_f32_16x16x32_bf16 v[28:31], v[12:15], v[148:151], 0
  v_mfma_f32_16x16x32_bf16 v[32:35], v[12:15], v[152:155], 0
  v_mfma_f32_16x16x32_bf16 v[36:39], v[12:15], v[156:159], 0
  v_mfma_f32_16x16x32_bf16 v[28:31], v[16:19], v[184:187], v[28:31]
  v_mfma_f32_16x16x32_bf16 v[32:35], v[16:19], v[188:191], v[32:35]
  v_mfma_f32_16x16x32_bf16 v[36:39], v[16:19], v[192:195], v[36:39]
  v_mfma_f32_16x16x32_bf16 v[28:31], v[20:23], v[220:223], v[28:31]
  v_mfma_f32_16x16x32_bf16 v[32:35], v[20:23], v[224:227], v[32:35]
  v_mfma_f32_16x16x32_bf16 v[36:39], v[20:23], v[228:231], v[36:39]
  v_mfma_f32_16x16x32_bf16 v[28:31], v[24:27], a[0:3], v[28:31]
  v_mfma_f32_16x16x32_bf16 v[32:35], v[24:27], a[4:7], v[32:35]
  v_mfma_f32_16x16x32_bf16 v[36:39], v[24:27], a[8:11], v[36:39]
  s_nop 5
  v_cndmask_b32 v40, v40, v28, s[64:65]
  v_mov_b32 v41, v32
  v_cndmask_b32 v41, v41, v36, s[60:61]
  v_mfma_f32_16x16x32_bf16 v[28:31], v[12:15], v[160:163], 0
  v_mfma_f32_16x16x32_bf16 v[32:35], v[12:15], v[164:167], 0
  v_mfma_f32_16x16x32_bf16 v[36:39], v[12:15], v[168:171], 0
  v_mfma_f32_16x16x32_bf16 v[28:31], v[16:19], v[196:199], v[28:31]
  v_mfma_f32_16x16x32_bf16 v[32:35], v[16:19], v[200:203], v[32:35]
  v_mfma_f32_16x16x32_bf16 v[36:39], v[16:19], v[204:207], v[36:39]
  v_mfma_f32_16x16x32_bf16 v[28:31], v[20:23], v[232:235], v[28:31]
  v_mfma_f32_16x16x32_bf16 v[32:35], v[20:23], v[236:239], v[32:35]
  v_mfma_f32_16x16x32_bf16 v[36:39], v[20:23], v[240:243], v[36:39]
  v_mfma_f32_16x16x32_bf16 v[28:31], v[24:27], a[12:15], v[28:31]
  v_mfma_f32_16x16x32_bf16 v[32:35], v[24:27], a[16:19], v[32:35]
  v_mfma_f32_16x16x32_bf16 v[36:39], v[24:27], a[20:23], v[36:39]
  s_nop 5
  v_cndmask_b32 v41, v41, v28, s[62:63]
  v_cndmask_b32 v41, v41, v32, s[64:65]
  v_mov_b32 v42, v36
  s_mul_i32 s10, s3, 576
  s_add_u32 s10, s10, 155136
  v_lshl_add_u32 v33, v0, 2, s10
  ds_write_b32 v33, v40
  ds_write_b32 v33, v41 offset:256
  s_mov_b32 exec_lo, 0xffff
  s_mov_b32 exec_hi, 0
  ds_write_b32 v33, v42 offset:512
  s_mov_b64 exec, -1
  s_waitcnt lgkmcnt(0)
  s_barrier
  s_cmp_eq_u32 s3, 0
  s_cbranch_scc0 Lbp_73
  v_lshlrev_b32 v33, 4, v0
  v_add_u32 v34, 155136, v33
  ds_read_b128 v[12:15], v34 offset:0
  ds_read_b128 v[16:19], v34 offset:576
  ds_read_b128 v[20:23], v34 offset:1152
  ds_read_b128 v[24:27], v34 offset:1728
  s_mul_i32 s10, s8, 18432
  s_mul_i32 s11, s5, 2304
  s_add_u32 s10, s10, s11
  s_mul_i32 s11, s6, 576
  s_add_u32 s10, s10, s11
  s_add_u32 s10, s10, 688128
  s_waitcnt lgkmcnt(0)
  v_add_f32 v12, v12, v16
  v_add_f32 v20, v20, v24
  v_add_f32 v13, v13, v17
  v_add_f32 v21, v21, v25
  v_add_f32 v14, v14, v18
  v_add_f32 v22, v22, v26
  v_add_f32 v15, v15, v19
  v_add_f32 v23, v23, v27
  v_add_f32 v12, v12, v20
  v_add_f32 v13, v13, v21
  v_add_f32 v14, v14, v22
  v_add_f32 v15, v15, v23
  s_mov_b32 exec_lo, -1
  s_mov_b32 exec_hi, 0xf
  s_cmp_eq_u32 s9, 0
  s_cbranch_scc1 Lsf_74
  buffer_store_dwordx4 v[12:15], v33, s[16:19], s10 offen
  s_nop 0
  s_branch Lsd_75
Lsf_74:
  buffer_store_dwordx4 v[12:15], v33, s[16:19], s10 offen sc0 sc1
Lsd_75:
  s_mov_b64 exec, -1
Lbp_73:
  s_mul_i32 s12, s8, 18432
  s_add_u32 s12, s12, 688128
  s_add_u32 s70, s12, 0
  s_add_u32 s71, s12, 2304
  s_add_u32 s72, s12, 4608
  s_add_u32 s73, s12, 6912
  s_add_u32 s74, s12, 9216
  s_add_u32 s75, s12, 11520
  s_add_u32 s76, s12, 13824
  s_add_u32 s77, s12, 16128
  s_mov_b32 exec_lo, -1
  s_mov_b32 exec_hi, 0xf
  s_mov_b32 s13, 0
Lgv_76:
  buffer_load_dwordx4 v[12:15], v1, s[16:19], s70 offen sc1
  buffer_load_dwordx4 v[16:19], v1, s[16:19], s71 offen sc1
  buffer_load_dwordx4 v[20:23], v1, s[16:19], s72 offen sc1
  buffer_load_dwordx4 v[24:27], v1, s[16:19], s73 offen sc1
  buffer_load_dwordx4 v[28:31], v1, s[16:19], s74 offen sc1
  buffer_load_dwordx4 v[32:35], v1, s[16:19], s75 offen sc1
  buffer_load_dwordx4 v[36:39], v1, s[16:19], s76 offen sc1
  buffer_load_dwordx4 v[40:43], v1, s[16:19], s77 offen sc1
  s_add_u32 s13, s13, 1
  s_cmp_ge_u32 s13, 20000
  s_waitcnt vmcnt(0)
  s_cbranch_scc1 Lgr_77
  v_max_u32 v44, v12, v40
  v_cmp_eq_u32 vcc, -1, v44
  s_nop 3
  s_cbranch_vccnz Lgv_76
Lgr_77:
  v_add_f32 v12, v12, v16
  v_add_f32 v20, v20, v24
  v_add_f32 v28, v28, v32
  v_add_f32 v36, v36, v40
  v_add_f32 v13, v13, v17
  v_add_f32 v21, v21, v25
  v_add_f32 v29, v29, v33
  v_add_f32 v37, v37, v41
  v_add_f32 v14, v14, v18
  v_add_f32 v22, v22, v26
  v_add_f32 v30, v30, v34
  v_add_f32 v38, v38, v42
  v_add_f32 v15, v15, v19
  v_add_f32 v23, v23, v27
  v_add_f32 v31, v31, v35
  v_add_f32 v39, v39, v43
  v_add_f32 v12, v12, v20
  v_add_f32 v28, v28, v36
  v_add_f32 v13, v13, v21
  v_add_f32 v29, v29, v37
  v_add_f32 v14, v14, v22
  v_add_f32 v30, v30, v38
  v_add_f32 v15, v15, v23
  v_add_f32 v31, v31, v39
  v_add_f32 v12, v12, v28
  v_add_f32 v13, v13, v29
  v_add_f32 v14, v14, v30
  v_add_f32 v15, v15, v31
  v_add_f32 v16, v12, v13
  v_add_f32 v17, v14, v15
  v_cmp_u_f32 vcc, v16, v17
  s_nop 3
  s_cbranch_vccz Lgk_78
  s_cmp_lt_u32 s13, 20000
  s_cbranch_scc1 Lgv_76
Lgk_78:
  v_add_f32 v5, v5, v12
  v_add_f32 v6, v6, v13
  v_add_f32 v7, v7, v14
  v_add_f32 v8, v8, v15
  s_mov_b64 exec, -1
  v_mov_b32 v12, 0
  v_mov_b32 v13, 0
  v_lshrrev_b32 v16, 1, v1
  v_add_u32 v16, 151552, v16
  s_mov_b32 exec_lo, -1
  s_mov_b32 exec_hi, 0xf
  v_cvt_pk_bf16_f32 v14, v5, v6
  v_cvt_pk_bf16_f32 v15, v7, v8
  v_add_f32 v12, v5, v6
  v_mul_f32 v13, v5, v5
  ds_write_b64 v16, v[14:15]
  v_add_f32 v17, v7, v8
  v_fmac_f32 v13, v6, v6
  v_add_f32 v12, v12, v17
  v_fmac_f32 v13, v7, v7
  v_fmac_f32 v13, v8, v8
  s_mov_b64 exec, -1
  v_add_f32_dpp v12, v12, v12 row_ror:8 row_mask:0xf bank_mask:0xf
  v_add_f32_dpp v13, v13, v13 row_ror:8 row_mask:0xf bank_mask:0xf
  s_nop 0
  v_add_f32_dpp v12, v12, v12 row_ror:4 row_mask:0xf bank_mask:0xf
  v_add_f32_dpp v13, v13, v13 row_ror:4 row_mask:0xf bank_mask:0xf
  s_nop 0
  v_add_f32_dpp v12, v12, v12 row_ror:2 row_mask:0xf bank_mask:0xf
  v_add_f32_dpp v13, v13, v13 row_ror:2 row_mask:0xf bank_mask:0xf
  s_nop 0
  v_add_f32_dpp v12, v12, v12 row_ror:1 row_mask:0xf bank_mask:0xf
  v_add_f32_dpp v13, v13, v13 row_ror:1 row_mask:0xf bank_mask:0xf
  s_nop 0
  v_add_f32_dpp v12, v12, v12 row_bcast:15 row_mask:0xa bank_mask:0xf
  v_add_f32_dpp v13, v13, v13 row_bcast:15 row_mask:0xa bank_mask:0xf
  s_nop 0
  v_add_f32_dpp v12, v12, v12 row_bcast:31 row_mask:0xc bank_mask:0xf
  v_add_f32_dpp v13, v13, v13 row_bcast:31 row_mask:0xc bank_mask:0xf
  v_lshrrev_b32 v14, 4, v0
  s_lshl_b32 s10, s3, 5
  s_add_u32 s10, s10, 157440
  v_lshl_add_u32 v14, v14, 3, s10
  ds_write_b64 v14, v[12:13]
  s_waitcnt lgkmcnt(0)
  s_barrier
  ds_read_b128 v[20:23], v2 offset:0
  ds_read_b128 v[24:27], v2 offset:64
  ds_read_b128 v[28:31], v2 offset:128
  ds_read_b128 v[32:35], v2 offset:192
  s_waitcnt lgkmcnt(3)
  v_mfma_f32_16x16x32_bf16 v[12:15], v[20:23], a[24:27], 0
  v_mfma_f32_16x16x32_bf16 v[16:19], v[20:23], a[28:31], 0
  ds_read_b128 v[20:23], v2 offset:256
  s_waitcnt lgkmcnt(3)
  v_mfma_f32_16x16x32_bf16 v[12:15], v[24:27], a[32:35], v[12:15]
  v_mfma_f32_16x16x32_bf16 v[16:19], v[24:27], a[36:39], v[16:19]
  ds_read_b128 v[24:27], v2 offset:320
  s_waitcnt lgkmcnt(3)
  v_mfma_f32_16x16x32_bf16 v[12:15], v[28:31], a[40:43], v[12:15]
  v_mfma_f32_16x16x32_bf16 v[16:19], v[28:31], a[44:47], v[16:19]
  ds_read_b128 v[28:31], v2 offset:384
  s_waitcnt lgkmcnt(3)
  v_mfma_f32_16x16x32_bf16 v[12:15], v[32:35], a[48:51], v[12:15]
  v_mfma_f32_16x16x32_bf16 v[16:19], v[32:35], a[52:55], v[16:19]
  ds_read_b128 v[32:35], v2 offset:448
  s_waitcnt lgkmcnt(3)
  v_mfma_f32_16x16x32_bf16 v[12:15], v[20:23], a[56:59], v[12:15]
  v_mfma_f32_16x16x32_bf16 v[16:19], v[20:23], a[60:63], v[16:19]
  ds_read_b128 v[20:23], v2 offset:512
  s_waitcnt lgkmcnt(3)
  v_mfma_f32_16x16x32_bf16 v[12:15], v[24:27], a[64:67], v[12:15]
  v_mfma_f32_16x16x32_bf16 v[16:19], v[24:27], a[68:71], v[16:19]
  ds_read_b128 v[24:27], v2 offset:576
  s_waitcnt lgkmcnt(3)
  v_mfma_f32_16x16x32_bf16 v[12:15], v[28:31], a[72:75], v[12:15]
  v_mfma_f32_16x16x32_bf16 v[16:19], v[28:31], a[76:79], v[16:19]
  ds_read_b128 v[28:31], v2 offset:640
  s_waitcnt lgkmcnt(3)
  v_mfma_f32_16x16x32_bf16 v[12:15], v[32:35], a[80:83], v[12:15]
  v_mfma_f32_16x16x32_bf16 v[16:19], v[32:35], a[84:87], v[16:19]
  ds_read_b128 v[32:35], v2 offset:704
  s_waitcnt lgkmcnt(3)
  v_mfma_f32_16x16x32_bf16 v[12:15], v[20:23], a[88:91], v[12:15]
  v_mfma_f32_16x16x32_bf16 v[16:19], v[20:23], a[92:95], v[16:19]
  ds_read_b128 v[20:23], v2 offset:768
  s_waitcnt lgkmcnt(3)
  v_mfma_f32_16x16x32_bf16 v[12:15], v[24:27], a[96:99], v[12:15]
  v_mfma_f32_16x16x32_bf16 v[16:19], v[24:27], a[100:103], v[16:19]
  ds_read_b128 v[24:27], v2 offset:832
  s_waitcnt lgkmcnt(3)
  v_mfma_f32_16x16x32_bf16 v[12:15], v[28:31], a[104:107], v[12:15]
  v_mfma_f32_16x16x32_bf16 v[16:19], v[28:31], a[108:111], v[16:19]
  ds_read_b128 v[28:31], v2 offset:896
  s_waitcnt lgkmcnt(3)
  v_mfma_f32_16x16x32_bf16 v[12:15], v[32:35], a[112:115], v[12:15]
  v_mfma_f32_16x16x32_bf16 v[16:19], v[32:35], a[116:119], v[16:19]
  ds_read_b128 v[32:35], v2 offset:960
  s_waitcnt lgkmcnt(3)
  v_mfma_f32_16x16x32_bf16 v[12:15], v[20:23], a[120:123], v[12:15]
  v_mfma_f32_16x16x32_bf16 v[16:19], v[20:23], a[124:127], v[16:19]
  v_mov_b32 v38, 157440
  ds_read_b64 v[40:41], v38 offset:24
  ds_read_b64 v[42:43], v38 offset:56
  ds_read_b64 v[44:45], v38 offset:88
  ds_read_b64 v[46:47], v38 offset:120
  ds_read_b128 v[20:23], v2 offset:1024
  s_waitcnt lgkmcnt(7)
  v_mfma_f32_16x16x32_bf16 v[12:15], v[24:27], a[128:131], v[12:15]
  v_mfma_f32_16x16x32_bf16 v[16:19], v[24:27], a[132:135], v[16:19]
  ds_read_b128 v[24:27], v2 offset:1088
  s_waitcnt lgkmcnt(7)
  v_mfma_f32_16x16x32_bf16 v[12:15], v[28:31], a[136:139], v[12:15]
  v_mfma_f32_16x16x32_bf16 v[16:19], v[28:31], a[140:143], v[16:19]
  s_waitcnt lgkmcnt(6)
  v_mfma_f32_16x16x32_bf16 v[12:15], v[32:35], a[144:147], v[12:15]
  v_mfma_f32_16x16x32_bf16 v[16:19], v[32:35], a[148:151], v[16:19]
  s_waitcnt lgkmcnt(1)
  v_mfma_f32_16x16x32_bf16 v[12:15], v[20:23], a[152:155], v[12:15]
  v_mfma_f32_16x16x32_bf16 v[16:19], v[20:23], a[156:159], v[16:19]
  s_waitcnt lgkmcnt(0)
  v_mfma_f32_16x16x32_bf16 v[12:15], v[24:27], a[160:163], v[12:15]
  v_mfma_f32_16x16x32_bf16 v[16:19], v[24:27], a[164:167], v[16:19]
  v_add_f32 v40, v40, v42
  v_add_f32 v41, v41, v43
  v_add_f32 v44, v44, v46
  v_add_f32 v45, v45, v47
  v_add_f32 v40, v40, v44
  v_add_f32 v41, v41, v45
  v_mul_f32 v36, 0x3ae38e39, v40
  v_mul_f32 v37, 0x3ae38e39, v41
  v_fma_f32 v37, -v36, v36, v37
  v_max_f32 v37, 0, v37
  v_add_f32 v37, 0x3727c5ac, v37
  v_rsq_f32 v37, v37
  v_readfirstlane_b32 s70, v36
  v_readfirstlane_b32 s71, v37
  s_cmp_eq_u32 s3, 3
  s_nop 2
  s_cbranch_scc0 Lg3_79
  v_lshlrev_b32 v32, 4, v0
  v_add_u32 v32, 133120, v32
  ds_read_b128 v[36:39], v32 offset:0
  ds_read_b128 v[24:27], v2 offset:0
  ds_read_b128 v[40:43], v32 offset:1024
  ds_read_b128 v[28:31], v2 offset:64
  ds_read_b128 v[44:47], v32 offset:2048
  s_waitcnt lgkmcnt(4)
  s_waitcnt lgkmcnt(3)
  v_mfma_f32_16x16x32_bf16 v[20:23], v[24:27], v[36:39], 0
  ds_read_b128 v[24:27], v2 offset:128
  ds_read_b128 v[36:39], v32 offset:3072
  s_waitcnt lgkmcnt(4)
  s_waitcnt lgkmcnt(3)
  v_mfma_f32_16x16x32_bf16 v[20:23], v[28:31], v[40:43], v[20:23]
  ds_read_b128 v[28:31], v2 offset:192
  ds_read_b128 v[40:43], v32 offset:4096
  s_waitcnt lgkmcnt(4)
  s_waitcnt lgkmcnt(3)
  v_mfma_f32_16x16x32_bf16 v[20:23], v[24:27], v[44:47], v[20:23]
  ds_read_b128 v[24:27], v2 offset:256
  ds_read_b128 v[44:47], v32 offset:5120
  s_waitcnt lgkmcnt(4)
  s_waitcnt lgkmcnt(3)
  v_mfma_f32_16x16x32_bf16 v[20:23], v[28:31], v[36:39], v[20:23]
  ds_read_b128 v[28:31], v2 offset:320
  ds_read_b128 v[36:39], v32 offset:6144
  s_waitcnt lgkmcnt(4)
  s_waitcnt lgkmcnt(3)
  v_mfma_f32_16x16x32_bf16 v[20:23], v[24:27], v[40:43], v[20:23]
  ds_read_b128 v[24:27], v2 offset:384
  ds_read_b128 v[40:43], v32 offset:7168
  s_waitcnt lgkmcnt(4)
  s_waitcnt lgkmcnt(3)
  v_mfma_f32_16x16x32_bf16 v[20:23], v[28:31], v[44:47], v[20:23]
  ds_read_b128 v[28:31], v2 offset:448
  ds_read_b128 v[44:47], v32 offset:8192
  s_waitcnt lgkmcnt(4)
  s_waitcnt lgkmcnt(3)
  v_mfma_f32_16x16x32_bf16 v[20:23], v[24:27], v[36:39], v[20:23]
  ds_read_b128 v[24:27], v2 offset:512
  ds_read_b128 v[36:39], v32 offset:9216
  s_waitcnt lgkmcnt(4)
  s_waitcnt lgkmcnt(3)
  v_mfma_f32_16x16x32_bf16 v[20:23], v[28:31], v[40:43], v[20:23]
  ds_read_b128 v[28:31], v2 offset:576
  ds_read_b128 v[40:43], v32 offset:10240
  s_waitcnt lgkmcnt(4)
  s_waitcnt lgkmcnt(3)
  v_mfma_f32_16x16x32_bf16 v[20:23], v[24:27], v[44:47], v[20:23]
  ds_read_b128 v[24:27], v2 offset:640
  ds_read_b128 v[44:47], v32 offset:11264
  s_waitcnt lgkmcnt(4)
  s_waitcnt lgkmcnt(3)
  v_mfma_f32_16x16x32_bf16 v[20:23], v[28:31], v[36:39], v[20:23]
  ds_read_b128 v[28:31], v2 offset:704
  ds_read_b128 v[36:39], v32 offset:12288
  s_waitcnt lgkmcnt(4)
  s_waitcnt lgkmcnt(3)
  v_mfma_f32_16x16x32_bf16 v[20:23], v[24:27], v[40:43], v[20:23]
  ds_read_b128 v[24:27], v2 offset:768
  ds_read_b128 v[40:43], v32 offset:13312
  s_waitcnt lgkmcnt(4)
  s_waitcnt lgkmcnt(3)
  v_mfma_f32_16x16x32_bf16 v[20:23], v[28:31], v[44:47], v[20:23]
  ds_read_b128 v[28:31], v2 offset:832
  ds_read_b128 v[44:47], v32 offset:14336
  s_waitcnt lgkmcnt(4)
  s_waitcnt lgkmcnt(3)
  v_mfma_f32_16x16x32_bf16 v[20:23], v[24:27], v[36:39], v[20:23]
  ds_read_b128 v[24:27], v2 offset:896
  ds_read_b128 v[36:39], v32 offset:15360
  s_waitcnt lgkmcnt(4)
  s_waitcnt lgkmcnt(3)
  v_mfma_f32_16x16x32_bf16 v[20:23], v[28:31], v[40:43], v[20:23]
  ds_read_b128 v[28:31], v2 offset:960
  ds_read_b128 v[40:43], v32 offset:16384
  s_waitcnt lgkmcnt(4)
  s_waitcnt lgkmcnt(3)
  v_mfma_f32_16x16x32_bf16 v[20:23], v[24:27], v[44:47], v[20:23]
  ds_read_b128 v[24:27], v2 offset:1024
  ds_read_b128 v[44:47], v32 offset:17408
  s_waitcnt lgkmcnt(4)
  s_waitcnt lgkmcnt(3)
  v_mfma_f32_16x16x32_bf16 v[20:23], v[28:31], v[36:39], v[20:23]
  ds_read_b128 v[28:31], v2 offset:1088
  s_waitcnt lgkmcnt(3)
  s_waitcnt lgkmcnt(2)
  v_mfma_f32_16x16x32_bf16 v[20:23], v[24:27], v[40:43], v[20:23]
  s_waitcnt lgkmcnt(1)
  s_waitcnt lgkmcnt(0)
  v_mfma_f32_16x16x32_bf16 v[20:23], v[28:31], v[44:47], v[20:23]
Lg3_79:
  v_mov_b32 v24, v12
  v_cndmask_b32 v24, v24, v16, s[60:61]
  s_nop 5
  v_cndmask_b32 v24, v24, v20, s[62:63]
  v_mul_f32 v25, s70, v4
  v_and_b32 v26, 0xffff0000, v9
  v_sub_f32 v24, v24, v25
  v_fma_f32 v24, v24, s71, v26
  v_mul_f32 v25, v24, v24
  v_mov_b32 v26, 0xc0135761
  v_mov_b32 v27, 0xbdd2d3e8
  v_fma_f32 v25, v25, v27, v26
  v_mul_f32 v25, v25, v24
  v_exp_f32 v25, v25
  s_nop 0
  v_add_f32 v25, 1.0, v25
  v_rcp_f32 v25, v25
  s_nop 0
  v_mul_f32 v24, v24, v25
  s_nop 1
  v_mov_b32_dpp v25, v24 quad_perm:[0,0,2,2] row_mask:0xf bank_mask:0xf
  v_mov_b32_dpp v26, v24 quad_perm:[1,1,3,3] row_mask:0xf bank_mask:0xf
  v_cvt_pk_bf16_f32 v25, v25, v26
  s_mul_i32 s10, s8, 9216
  s_mul_i32 s11, s4, 288
  s_add_u32 s10, s10, s11
  s_lshl_b32 s11, s3, 6
  s_add_u32 s10, s10, s11
  s_add_u32 s10, s10, 761856
  v_lshlrev_b32 v26, 1, v0
  s_mov_b32 exec_lo, 0x55555555
  s_cmp_eq_u32 s3, 3
  s_cselect_b32 exec_hi, 0x5555, 0
  s_cmp_eq_u32 s9, 0
  s_cbranch_scc1 Lsf_80
  buffer_store_dword v25, v26, s[16:19], s10 offen
  s_branch Lsd_81
Lsf_80:
  buffer_store_dword v25, v26, s[16:19], s10 offen sc0 sc1
Lsd_81:
  s_mov_b64 exec, -1
  s_mul_i32 s11, s8, 9216
  s_mul_i32 s10, s5, 1152
  s_add_u32 s11, s11, s10
  s_mul_i32 s10, s3, 288
  s_add_u32 s11, s11, s10
  s_add_u32 s11, s11, 761856
  v_lshlrev_b32 v17, 4, v0
  s_add_u32 s10, s10, 152832
  v_add_u32 v18, s10, v17
  v_mov_b32 v32, v10
  v_xor_b32 v33, 32, v10
  v_xor_b32 v34, 128, v10
  v_xor_b32 v35, 160, v10
  ds_read_b64_tr_b16 v[36:37], v32 offset:0
  ds_read_b64_tr_b16 v[38:39], v34 offset:1024
  ds_read_b64_tr_b16 v[40:41], v33 offset:0
  ds_read_b64_tr_b16 v[42:43], v35 offset:1024
  ds_read_b64_tr_b16 v[44:45], v32 offset:8192
  ds_read_b64_tr_b16 v[46:47], v34 offset:9216
  s_mov_b32 exec_lo, 0x3ffff
  s_mov_b32 exec_hi, 0
  s_mov_b32 s13, 0
Lpl_82:
  buffer_load_dwordx4 v[12:15], v17, s[16:19], s11 offen sc1
  s_waitcnt vmcnt(0)
  v_max3_u32 v16, v12, v13, v14
  v_max_u32 v16, v16, v15
  v_cmp_eq_u32 vcc, -1, v16
  s_nop 3
  s_cbranch_vccz Lpk_83
  s_add_u32 s13, s13, 1
  s_cmp_lt_u32 s13, 20000
  s_cbranch_scc1 Lpl_82
Lpk_83:
  ds_write_b128 v18, v[12:15]
  s_mov_b64 exec, -1
  s_waitcnt lgkmcnt(0)
  s_waitcnt lgkmcnt(0)
  s_barrier
  ds_read_b128 v[20:23], v2 offset:1280
  ds_read_b128 v[24:27], v2 offset:1984
  ds_read_b128 v[28:31], v2 offset:1344
  s_waitcnt lgkmcnt(2)
  v_mfma_f32_16x16x32_bf16 v[12:15], v[20:23], a[168:171], 0
  v_mfma_f32_16x16x32_bf16 v[16:19], v[20:23], a[172:175], 0
  ds_read_b128 v[20:23], v2 offset:2048
  s_waitcnt lgkmcnt(2)
  v_mfma_f32_16x16x32_bf16 v[12:15], v[24:27], v[36:39], v[12:15]
  ds_read_b64_tr_b16 v[36:37], v33 offset:8192
  ds_read_b64_tr_b16 v[38:39], v35 offset:9216
  v_mfma_f32_16x16x32_bf16 v[16:19], v[24:27], v[40:43], v[16:19]
  ds_read_b64_tr_b16 v[40:41], v32 offset:16384
  ds_read_b64_tr_b16 v[42:43], v34 offset:17408
  ds_read_b128 v[24:27], v2 offset:1408
  s_waitcnt lgkmcnt(6)
  v_mfma_f32_16x16x32_bf16 v[12:15], v[28:31], a[176:179], v[12:15]
  v_mfma_f32_16x16x32_bf16 v[16:19], v[28:31], a[180:183], v[16:19]
  ds_read_b128 v[28:31], v2 offset:2112
  s_waitcnt lgkmcnt(6)
  v_mfma_f32_16x16x32_bf16 v[12:15], v[20:23], v[44:47], v[12:15]
  ds_read_b64_tr_b16 v[44:45], v33 offset:16384
  ds_read_b64_tr_b16 v[46:47], v35 offset:17408
  s_waitcnt lgkmcnt(6)
  v_mfma_f32_16x16x32_bf16 v[16:19], v[20:23], v[36:39], v[16:19]
  ds_read_b64_tr_b16 v[36:37], v32 offset:24576
  ds_read_b64_tr_b16 v[38:39], v34 offset:25600
  ds_read_b128 v[20:23], v2 offset:1472
  s_waitcnt lgkmcnt(6)
  v_mfma_f32_16x16x32_bf16 v[12:15], v[24:27], a[184:187], v[12:15]
  v_mfma_f32_16x16x32_bf16 v[16:19], v[24:27], a[188:191], v[16:19]
  ds_read_b128 v[24:27], v2 offset:2176
  s_waitcnt lgkmcnt(6)
  v_mfma_f32_16x16x32_bf16 v[12:15], v[28:31], v[40:43], v[12:15]
  ds_read_b64_tr_b16 v[40:41], v33 offset:24576
  ds_read_b64_tr_b16 v[42:43], v35 offset:25600
  s_waitcnt lgkmcnt(6)
  v_mfma_f32_16x16x32_bf16 v[16:19], v[28:31], v[44:47], v[16:19]
  ds_read_b64_tr_b16 v[44:45], v32 offset:32768
  ds_read_b64_tr_b16 v[46:47], v34 offset:33792
  ds_read_b128 v[28:31], v2 offset:1536
  s_waitcnt lgkmcnt(6)
  v_mfma_f32_16x16x32_bf16 v[12:15], v[20:23], a[192:195], v[12:15]
  v_mfma_f32_16x16x32_bf16 v[16:19], v[20:23], a[196:199], v[16:19]
  ds_read_b128 v[20:23], v2 offset:2240
  s_waitcnt lgkmcnt(6)
  v_mfma_f32_16x16x32_bf16 v[12:15], v[24:27], v[36:39], v[12:15]
  ds_read_b64_tr_b16 v[36:37], v33 offset:32768
  ds_read_b64_tr_b16 v[38:39], v35 offset:33792
  s_waitcnt lgkmcnt(6)
  v_mfma_f32_16x16x32_bf16 v[16:19], v[24:27], v[40:43], v[16:19]
  ds_read_b64_tr_b16 v[40:41], v32 offset:40960
  ds_read_b64_tr_b16 v[42:43], v34 offset:41984
  ds_read_b128 v[24:27], v2 offset:1600
  s_waitcnt lgkmcnt(6)
  v_mfma_f32_16x16x32_bf16 v[12:15], v[28:31], a[200:203], v[12:15]
  v_mfma_f32_16x16x32_bf16 v[16:19], v[28:31], a[204:207], v[16:19]
  ds_read_b128 v[28:31], v2 offset:2304
  s_waitcnt lgkmcnt(6)
  v_mfma_f32_16x16x32_bf16 v[12:15], v[20:23], v[44:47], v[12:15]
  ds_read_b64_tr_b16 v[44:45], v33 offset:40960
  ds_read_b64_tr_b16 v[46:47], v35 offset:41984
  s_waitcnt lgkmcnt(6)
  v_mfma_f32_16x16x32_bf16 v[16:19], v[20:23], v[36:39], v[16:19]
  ds_read_b64_tr_b16 v[36:37], v32 offset:49152
  ds_read_b64_tr_b16 v[38:39], v34 offset:50176
  ds_read_b128 v[20:23], v2 offset:1664
  s_waitcnt lgkmcnt(6)
  v_mfma_f32_16x16x32_bf16 v[12:15], v[24:27], a[208:211], v[12:15]
  v_mfma_f32_16x16x32_bf16 v[16:19], v[24:27], a[212:215], v[16:19]
  ds_read_b128 v[24:27], v2 offset:2368
  s_waitcnt lgkmcnt(6)
  v_mfma_f32_16x16x32_bf16 v[12:15], v[28:31], v[40:43], v[12:15]
  ds_read_b64_tr_b16 v[40:41], v33 offset:49152
  ds_read_b64_tr_b16 v[42:43], v35 offset:50176
  s_waitcnt lgkmcnt(6)
  v_mfma_f32_16x16x32_bf16 v[16:19], v[28:31], v[44:47], v[16:19]
  ds_read_b128 v[28:31], v2 offset:1728
  s_waitcnt lgkmcnt(4)
  v_mfma_f32_16x16x32_bf16 v[12:15], v[20:23], a[216:219], v[12:15]
  v_mfma_f32_16x16x32_bf16 v[16:19], v[20:23], a[220:223], v[16:19]
  ds_read_b128 v[20:23], v2 offset:1792
  s_waitcnt lgkmcnt(4)
  v_mfma_f32_16x16x32_bf16 v[12:15], v[24:27], v[36:39], v[12:15]
  s_waitcnt lgkmcnt(2)
  v_mfma_f32_16x16x32_bf16 v[16:19], v[24:27], v[40:43], v[16:19]
  ds_read_b128 v[24:27], v2 offset:1856
  s_waitcnt lgkmcnt(2)
  v_mfma_f32_16x16x32_bf16 v[12:15], v[28:31], a[224:227], v[12:15]
  v_mfma_f32_16x16x32_bf16 v[16:19], v[28:31], a[228:231], v[16:19]
  ds_read_b128 v[28:31], v2 offset:1920
  s_waitcnt lgkmcnt(2)
  v_mfma_f32_16x16x32_bf16 v[12:15], v[20:23], a[232:235], v[12:15]
  v_mfma_f32_16x16x32_bf16 v[16:19], v[20:23], a[236:239], v[16:19]
  s_waitcnt lgkmcnt(1)
  v_mfma_f32_16x16x32_bf16 v[12:15], v[24:27], a[240:243], v[12:15]
  v_mfma_f32_16x16x32_bf16 v[16:19], v[24:27], a[244:247], v[16:19]
  s_waitcnt lgkmcnt(0)
  v_mfma_f32_16x16x32_bf16 v[12:15], v[28:31], a[248:251], v[12:15]
  v_mfma_f32_16x16x32_bf16 v[16:19], v[28:31], a[252:255], v[16:19]
  s_cmp_eq_u32 s3, 3
  s_nop 5
  s_cbranch_scc0 Lg3_84
  v_lshlrev_b32 v32, 4, v0
  v_add_u32 v32, 114688, v32
  v_lshrrev_b32 v33, 4, v0
  v_bfe_u32 v34, v0, 2, 2
  v_lshl_add_u32 v33, v33, 3, v34
  v_lshlrev_b32 v33, 5, v33
  v_and_b32 v34, 3, v0
  v_lshl_add_u32 v33, v34, 3, v33
  v_add_u32 v33, 114688, v33
  ds_read_b128 v[36:39], v32 offset:0
  ds_read_b128 v[24:27], v2 offset:1280
  ds_read_b128 v[40:43], v32 offset:1024
  ds_read_b128 v[28:31], v2 offset:1344
  ds_read_b128 v[44:47], v32 offset:2048
  s_waitcnt lgkmcnt(4)
  s_waitcnt lgkmcnt(3)
  v_mfma_f32_16x16x32_bf16 v[20:23], v[24:27], v[36:39], 0
  ds_read_b128 v[24:27], v2 offset:1408
  ds_read_b128 v[36:39], v32 offset:3072
  s_waitcnt lgkmcnt(4)
  s_waitcnt lgkmcnt(3)
  v_mfma_f32_16x16x32_bf16 v[20:23], v[28:31], v[40:43], v[20:23]
  ds_read_b128 v[28:31], v2 offset:1472
  ds_read_b128 v[40:43], v32 offset:4096
  s_waitcnt lgkmcnt(4)
  s_waitcnt lgkmcnt(3)
  v_mfma_f32_16x16x32_bf16 v[20:23], v[24:27], v[44:47], v[20:23]
  ds_read_b128 v[24:27], v2 offset:1536
  ds_read_b128 v[44:47], v32 offset:5120
  s_waitcnt lgkmcnt(4)
  s_waitcnt lgkmcnt(3)
  v_mfma_f32_16x16x32_bf16 v[20:23], v[28:31], v[36:39], v[20:23]
  ds_read_b128 v[28:31], v2 offset:1600
  ds_read_b128 v[36:39], v32 offset:6144
  s_waitcnt lgkmcnt(4)
  s_waitcnt lgkmcnt(3)
  v_mfma_f32_16x16x32_bf16 v[20:23], v[24:27], v[40:43], v[20:23]
  ds_read_b128 v[24:27], v2 offset:1664
  ds_read_b128 v[40:43], v32 offset:7168
  s_waitcnt lgkmcnt(4)
  s_waitcnt lgkmcnt(3)
  v_mfma_f32_16x16x32_bf16 v[20:23], v[28:31], v[44:47], v[20:23]
  ds_read_b128 v[28:31], v2 offset:1728
  ds_read_b128 v[44:47], v32 offset:8192
  s_waitcnt lgkmcnt(4)
  s_waitcnt lgkmcnt(3)
  v_mfma_f32_16x16x32_bf16 v[20:23], v[24:27], v[36:39], v[20:23]
  ds_read_b128 v[24:27], v2 offset:1792
  ds_read_b128 v[36:39], v32 offset:9216
  s_waitcnt lgkmcnt(4)
  s_waitcnt lgkmcnt(3)
  v_mfma_f32_16x16x32_bf16 v[20:23], v[28:31], v[40:43], v[20:23]
  ds_read_b128 v[28:31], v2 offset:1856
  ds_read_b128 v[40:43], v32 offset:10240
  s_waitcnt lgkmcnt(4)
  s_waitcnt lgkmcnt(3)
  v_mfma_f32_16x16x32_bf16 v[20:23], v[24:27], v[44:47], v[20:23]
  ds_read_b128 v[24:27], v2 offset:1920
  ds_read_b64_tr_b16 v[44:45], v33 offset:11264
  ds_read_b64_tr_b16 v[46:47], v33 offset:11392
  s_waitcnt lgkmcnt(5)
  s_waitcnt lgkmcnt(4)
  v_mfma_f32_16x16x32_bf16 v[20:23], v[28:31], v[36:39], v[20:23]
  ds_read_b128 v[28:31], v2 offset:1984
  ds_read_b64_tr_b16 v[36:37], v33 offset:12288
  ds_read_b64_tr_b16 v[38:39], v33 offset:12416
  s_waitcnt lgkmcnt(6)
  s_waitcnt lgkmcnt(5)
  v_mfma_f32_16x16x32_bf16 v[20:23], v[24:27], v[40:43], v[20:23]
  ds_read_b128 v[24:27], v2 offset:2048
  ds_read_b64_tr_b16 v[40:41], v33 offset:13312
  ds_read_b64_tr_b16 v[42:43], v33 offset:13440
  s_waitcnt lgkmcnt(6)
  s_waitcnt lgkmcnt(5)
  v_mfma_f32_16x16x32_bf16 v[20:23], v[28:31], v[44:47], v[20:23]
  ds_read_b128 v[28:31], v2 offset:2112
  ds_read_b64_tr_b16 v[44:45], v33 offset:14336
  ds_read_b64_tr_b16 v[46:47], v33 offset:14464
  s_waitcnt lgkmcnt(6)
  s_waitcnt lgkmcnt(5)
  v_mfma_f32_16x16x32_bf16 v[20:23], v[24:27], v[36:39], v[20:23]
  ds_read_b128 v[24:27], v2 offset:2176
  ds_read_b64_tr_b16 v[36:37], v33 offset:15360
  ds_read_b64_tr_b16 v[38:39], v33 offset:15488
  s_waitcnt lgkmcnt(6)
  s_waitcnt lgkmcnt(5)
  v_mfma_f32_16x16x32_bf16 v[20:23], v[28:31], v[40:43], v[20:23]
  ds_read_b128 v[28:31], v2 offset:2240
  ds_read_b64_tr_b16 v[40:41], v33 offset:16384
  ds_read_b64_tr_b16 v[42:43], v33 offset:16512
  s_waitcnt lgkmcnt(6)
  s_waitcnt lgkmcnt(5)
  v_mfma_f32_16x16x32_bf16 v[20:23], v[24:27], v[44:47], v[20:23]
  ds_read_b128 v[24:27], v2 offset:2304
  ds_read_b64_tr_b16 v[44:45], v33 offset:17408
  ds_read_b64_tr_b16 v[46:47], v33 offset:17536
  s_waitcnt lgkmcnt(6)
  s_waitcnt lgkmcnt(5)
  v_mfma_f32_16x16x32_bf16 v[20:23], v[28:31], v[36:39], v[20:23]
  ds_read_b128 v[28:31], v2 offset:2368
  s_waitcnt lgkmcnt(4)
  s_waitcnt lgkmcnt(3)
  v_mfma_f32_16x16x32_bf16 v[20:23], v[24:27], v[40:43], v[20:23]
  s_waitcnt lgkmcnt(1)
  s_waitcnt lgkmcnt(0)
  v_mfma_f32_16x16x32_bf16 v[20:23], v[28:31], v[44:47], v[20:23]
Lg3_84:
  v_mov_b32 v24, v12
  v_cndmask_b32 v24, v24, v16, s[60:61]
  s_nop 5
  v_cndmask_b32 v24, v24, v20, s[62:63]
  v_lshlrev_b32 v25, 16, v9
  v_add_f32 v24, v24, v25
  s_mul_i32 s10, s8, 18432
  s_mul_i32 s11, s5, 2304
  s_add_u32 s10, s10, s11
  s_mul_i32 s11, s6, 576
  s_add_u32 s10, s10, s11
  s_lshl_b32 s11, s3, 7
  s_add_u32 s10, s10, s11
  s_add_u32 s10, s10, 798720
  v_lshlrev_b32 v26, 2, v0
  s_mov_b32 exec_lo, -1
  s_cmp_eq_u32 s3, 3
  s_cselect_b32 exec_hi, 0xffff, 0
  s_cmp_eq_u32 s9, 0
  s_cbranch_scc1 Lsf_85
  buffer_store_dword v24, v26, s[16:19], s10 offen
  s_branch Lsd_86
Lsf_85:
  buffer_store_dword v24, v26, s[16:19], s10 offen sc0 sc1
Lsd_86:
  s_mov_b64 exec, -1
  s_mul_i32 s12, s8, 18432
  s_add_u32 s12, s12, 798720
  s_add_u32 s70, s12, 0
  s_add_u32 s71, s12, 2304
  s_add_u32 s72, s12, 4608
  s_add_u32 s73, s12, 6912
  s_add_u32 s74, s12, 9216
  s_add_u32 s75, s12, 11520
  s_add_u32 s76, s12, 13824
  s_add_u32 s77, s12, 16128
  s_mov_b32 exec_lo, -1
  s_mov_b32 exec_hi, 0xf
  s_mov_b32 s13, 0
Lgv_87:
  buffer_load_dwordx4 v[12:15], v1, s[16:19], s70 offen sc1
  buffer_load_dwordx4 v[16:19], v1, s[16:19], s71 offen sc1
  buffer_load_dwordx4 v[20:23], v1, s[16:19], s72 offen sc1
  buffer_load_dwordx4 v[24:27], v1, s[16:19], s73 offen sc1
  buffer_load_dwordx4 v[28:31], v1, s[16:19], s74 offen sc1
  buffer_load_dwordx4 v[32:35], v1, s[16:19], s75 offen sc1
  buffer_load_dwordx4 v[36:39], v1, s[16:19], s76 offen sc1
  buffer_load_dwordx4 v[40:43], v1, s[16:19], s77 offen sc1
  s_add_u32 s13, s13, 1
  s_cmp_ge_u32 s13, 20000
  s_waitcnt vmcnt(0)
  s_cbranch_scc1 Lgr_88
  v_max_u32 v44, v12, v40
  v_cmp_eq_u32 vcc, -1, v44
  s_nop 3
  s_cbranch_vccnz Lgv_87
Lgr_88:
  v_add_f32 v12, v12, v16
  v_add_f32 v20, v20, v24
  v_add_f32 v28, v28, v32
  v_add_f32 v36, v36, v40
  v_add_f32 v13, v13, v17
  v_add_f32 v21, v21, v25
  v_add_f32 v29, v29, v33
  v_add_f32 v37, v37, v41
  v_add_f32 v14, v14, v18
  v_add_f32 v22, v22, v26
  v_add_f32 v30, v30, v34
  v_add_f32 v38, v38, v42
  v_add_f32 v15, v15, v19
  v_add_f32 v23, v23, v27
  v_add_f32 v31, v31, v35
  v_add_f32 v39, v39, v43
  v_add_f32 v12, v12, v20
  v_add_f32 v28, v28, v36
  v_add_f32 v13, v13, v21
  v_add_f32 v29, v29, v37
  v_add_f32 v14, v14, v22
  v_add_f32 v30, v30, v38
  v_add_f32 v15, v15, v23
  v_add_f32 v31, v31, v39
  v_add_f32 v12, v12, v28
  v_add_f32 v13, v13, v29
  v_add_f32 v14, v14, v30
  v_add_f32 v15, v15, v31
  v_add_f32 v16, v12, v13
  v_add_f32 v17, v14, v15
  v_cmp_u_f32 vcc, v16, v17
  s_nop 3
  s_cbranch_vccz Lgk_89
  s_cmp_lt_u32 s13, 20000
  s_cbranch_scc1 Lgv_87
Lgk_89:
  v_add_f32 v5, v5, v12
  v_add_f32 v6, v6, v13
  v_add_f32 v7, v7, v14
  v_add_f32 v8, v8, v15
  s_mov_b64 exec, -1
  s_bitcmp1_b32 s8, 0
  s_cbranch_scc1 Lodd_90
  s_lshr_b32 s12, s8, 1
  s_add_u32 s58, s12, 2
  s_branch L_E
L_q1:
  s_mul_i32 s10, s7, 1152
  v_lshrrev_b32 v14, 1, v1
  s_add_u32 s10, s10, 157696
  v_add_u32 v14, s10, v14
  ds_read_b64 v[12:13], v14
  s_waitcnt lgkmcnt(0)
  v_lshlrev_b32 v5, 16, v12
  v_and_b32 v6, 0xffff0000, v12
  v_lshlrev_b32 v7, 16, v13
  v_and_b32 v8, 0xffff0000, v13
  s_mov_b32 s58, s7
L_E:
  v_mov_b32 v12, 0
  v_mov_b32 v13, 0
  v_lshrrev_b32 v16, 1, v1
  v_add_u32 v16, 151552, v16
  s_mov_b32 exec_lo, -1
  s_mov_b32 exec_hi, 0xf
  v_cvt_pk_bf16_f32 v14, v5, v6
  v_cvt_pk_bf16_f32 v15, v7, v8
  v_add_f32 v12, v5, v6
  v_mul_f32 v13, v5, v5
  ds_write_b64 v16, v[14:15]
  v_add_f32 v17, v7, v8
  v_fmac_f32 v13, v6, v6
  v_add_f32 v12, v12, v17
  v_fmac_f32 v13, v7, v7
  v_fmac_f32 v13, v8, v8
  s_mov_b64 exec, -1
  v_add_f32_dpp v12, v12, v12 row_ror:8 row_mask:0xf bank_mask:0xf
  v_add_f32_dpp v13, v13, v13 row_ror:8 row_mask:0xf bank_mask:0xf
  s_nop 0
  v_add_f32_dpp v12, v12, v12 row_ror:4 row_mask:0xf bank_mask:0xf
  v_add_f32_dpp v13, v13, v13 row_ror:4 row_mask:0xf bank_mask:0xf
  s_nop 0
  v_add_f32_dpp v12, v12, v12 row_ror:2 row_mask:0xf bank_mask:0xf
  v_add_f32_dpp v13, v13, v13 row_ror:2 row_mask:0xf bank_mask:0xf
  s_nop 0
  v_add_f32_dpp v12, v12, v12 row_ror:1 row_mask:0xf bank_mask:0xf
  v_add_f32_dpp v13, v13, v13 row_ror:1 row_mask:0xf bank_mask:0xf
  s_nop 0
  v_add_f32_dpp v12, v12, v12 row_bcast:15 row_mask:0xa bank_mask:0xf
  v_add_f32_dpp v13, v13, v13 row_bcast:15 row_mask:0xa bank_mask:0xf
  s_nop 0
  v_add_f32_dpp v12, v12, v12 row_bcast:31 row_mask:0xc bank_mask:0xf
  v_add_f32_dpp v13, v13, v13 row_bcast:31 row_mask:0xc bank_mask:0xf
  v_lshrrev_b32 v14, 4, v0
  s_lshl_b32 s10, s3, 5
  s_add_u32 s10, s10, 157440
  v_lshl_add_u32 v14, v14, 3, s10
  ds_write_b64 v14, v[12:13]
  ds_read_b128 v[36:39], v3 offset:0
  ds_read_b128 v[40:43], v3 offset:1024
  ds_read_b128 v[44:47], v3 offset:8192
  s_waitcnt lgkmcnt(0)
  s_waitcnt lgkmcnt(0)
  s_barrier
  ds_read_b128 v[20:23], v2 offset:0
  ds_read_b128 v[24:27], v2 offset:704
  ds_read_b128 v[28:31], v2 offset:64
  ds_read_b128 v[32:35], v2 offset:768
  s_waitcnt lgkmcnt(3)
  v_mfma_f32_16x16x32_bf16 v[12:15], v[20:23], v[48:51], 0
  v_mfma_f32_16x16x32_bf16 v[16:19], v[20:23], v[52:55], 0
  ds_read_b128 v[20:23], v2 offset:128
  s_waitcnt lgkmcnt(3)
  v_mfma_f32_16x16x32_bf16 v[12:15], v[24:27], v[36:39], v[12:15]
  ds_read_b128 v[36:39], v3 offset:9216
  v_mfma_f32_16x16x32_bf16 v[16:19], v[24:27], v[40:43], v[16:19]
  ds_read_b128 v[40:43], v3 offset:16384
  ds_read_b128 v[24:27], v2 offset:832
  s_waitcnt lgkmcnt(5)
  v_mfma_f32_16x16x32_bf16 v[12:15], v[28:31], v[56:59], v[12:15]
  v_mfma_f32_16x16x32_bf16 v[16:19], v[28:31], v[60:63], v[16:19]
  ds_read_b128 v[28:31], v2 offset:192
  s_waitcnt lgkmcnt(5)
  v_mfma_f32_16x16x32_bf16 v[12:15], v[32:35], v[44:47], v[12:15]
  ds_read_b128 v[44:47], v3 offset:17408
  s_waitcnt lgkmcnt(4)
  v_mfma_f32_16x16x32_bf16 v[16:19], v[32:35], v[36:39], v[16:19]
  ds_read_b128 v[36:39], v3 offset:24576
  ds_read_b128 v[32:35], v2 offset:896
  v_mfma_f32_16x16x32_bf16 v[12:15], v[20:23], v[64:67], v[12:15]
  v_mfma_f32_16x16x32_bf16 v[16:19], v[20:23], v[68:71], v[16:19]
  ds_read_b128 v[20:23], v2 offset:256
  s_waitcnt lgkmcnt(5)
  v_mfma_f32_16x16x32_bf16 v[12:15], v[24:27], v[40:43], v[12:15]
  ds_read_b128 v[40:43], v3 offset:25600
  s_waitcnt lgkmcnt(4)
  v_mfma_f32_16x16x32_bf16 v[16:19], v[24:27], v[44:47], v[16:19]
  ds_read_b128 v[44:47], v3 offset:32768
  ds_read_b128 v[24:27], v2 offset:960
  v_mfma_f32_16x16x32_bf16 v[12:15], v[28:31], v[72:75], v[12:15]
  v_mfma_f32_16x16x32_bf16 v[16:19], v[28:31], v[76:79], v[16:19]
  ds_read_b128 v[28:31], v2 offset:320
  s_waitcnt lgkmcnt(5)
  v_mfma_f32_16x16x32_bf16 v[12:15], v[32:35], v[36:39], v[12:15]
  ds_read_b128 v[36:39], v3 offset:33792
  s_waitcnt lgkmcnt(4)
  v_mfma_f32_16x16x32_bf16 v[16:19], v[32:35], v[40:43], v[16:19]
  ds_read_b128 v[40:43], v3 offset:40960
  ds_read_b128 v[32:35], v2 offset:1024
  v_mfma_f32_16x16x32_bf16 v[12:15], v[20:23], v[80:83], v[12:15]
  v_mfma_f32_16x16x32_bf16 v[16:19], v[20:23], v[84:87], v[16:19]
  ds_read_b128 v[20:23], v2 offset:384
  s_waitcnt lgkmcnt(5)
  v_mfma_f32_16x16x32_bf16 v[12:15], v[24:27], v[44:47], v[12:15]
  ds_read_b128 v[44:47], v3 offset:41984
  s_waitcnt lgkmcnt(4)
  v_mfma_f32_16x16x32_bf16 v[16:19], v[24:27], v[36:39], v[16:19]
  ds_read_b128 v[36:39], v3 offset:49152
  ds_read_b128 v[24:27], v2 offset:1088
  v_mfma_f32_16x16x32_bf16 v[12:15], v[28:31], v[88:91], v[12:15]
  v_mfma_f32_16x16x32_bf16 v[16:19], v[28:31], v[92:95], v[16:19]
  ds_read_b128 v[28:31], v2 offset:448
  s_waitcnt lgkmcnt(5)
  v_mfma_f32_16x16x32_bf16 v[12:15], v[32:35], v[40:43], v[12:15]
  ds_read_b128 v[40:43], v3 offset:50176
  s_waitcnt lgkmcnt(4)
  v_mfma_f32_16x16x32_bf16 v[16:19], v[32:35], v[44:47], v[16:19]
  ds_read_b128 v[32:35], v2 offset:512
  v_mfma_f32_16x16x32_bf16 v[12:15], v[20:23], v[96:99], v[12:15]
  v_mfma_f32_16x16x32_bf16 v[16:19], v[20:23], v[100:103], v[16:19]
  ds_read_b128 v[20:23], v2 offset:576
  s_waitcnt lgkmcnt(4)
  v_mfma_f32_16x16x32_bf16 v[12:15], v[24:27], v[36:39], v[12:15]
  s_waitcnt lgkmcnt(2)
  v_mfma_f32_16x16x32_bf16 v[16:19], v[24:27], v[40:43], v[16:19]
  v_mov_b32 v38, 157440
  ds_read_b64 v[40:41], v38 offset:24
  ds_read_b64 v[42:43], v38 offset:56
  ds_read_b64 v[44:45], v38 offset:88
  ds_read_b64 v[46:47], v38 offset:120
  ds_read_b128 v[24:27], v2 offset:640
  v_mfma_f32_16x16x32_bf16 v[12:15], v[28:31], v[104:107], v[12:15]
  v_mfma_f32_16x16x32_bf16 v[16:19], v[28:31], v[108:111], v[16:19]
  s_waitcnt lgkmcnt(6)
  v_mfma_f32_16x16x32_bf16 v[12:15], v[32:35], v[112:115], v[12:15]
  v_mfma_f32_16x16x32_bf16 v[16:19], v[32:35], v[116:119], v[16:19]
  s_waitcnt lgkmcnt(5)
  v_mfma_f32_16x16x32_bf16 v[12:15], v[20:23], v[120:123], v[12:15]
  v_mfma_f32_16x16x32_bf16 v[16:19], v[20:23], v[124:127], v[16:19]
  s_waitcnt lgkmcnt(0)
  v_mfma_f32_16x16x32_bf16 v[12:15], v[24:27], v[128:131], v[12:15]
  v_mfma_f32_16x16x32_bf16 v[16:19], v[24:27], v[132:135], v[16:19]
  v_add_f32 v40, v40, v42
  v_add_f32 v41, v41, v43
  v_add_f32 v44, v44, v46
  v_add_f32 v45, v45, v47
  v_add_f32 v40, v40, v44
  v_add_f32 v41, v41, v45
  v_mul_f32 v36, 0x3ae38e39, v40
  v_mul_f32 v37, 0x3ae38e39, v41
  v_fma_f32 v37, -v36, v36, v37
  v_max_f32 v37, 0, v37
  v_add_f32 v37, 0x3727c5ac, v37
  v_rsq_f32 v37, v37
  v_mov_b32 v24, v12
  v_cndmask_b32 v24, v24, v16, s[60:61]
  v_mul_f32 v25, v36, v11
  v_sub_f32 v24, v24, v25
  v_mul_f32 v24, v24, v37
  s_nop 1
  v_mov_b32_dpp v25, v24 quad_perm:[0,0,2,2] row_mask:0xf bank_mask:0xf
  v_mov_b32_dpp v26, v24 quad_perm:[1,1,3,3] row_mask:0xf bank_mask:0xf
  v_cvt_pk_bf16_f32 v25, v25, v26
  s_lshl_b32 s10, s58, 13
  s_lshl_b32 s11, s4, 8
  s_add_u32 s10, s10, s11
  s_lshl_b32 s11, s3, 6
  s_add_u32 s10, s10, s11
  s_add_u32 s10, s10, 655360
  v_lshlrev_b32 v26, 1, v0
  s_mov_b32 exec_lo, 0x55555555
  s_mov_b32 exec_hi, 0
  buffer_store_dword v25, v26, s[16:19], s10 offen sc0 sc1
  s_mov_b64 exec, -1
  s_add_u32 s7, s7, 1
  s_cmp_eq_u32 s7, 1
  s_cbranch_scc0 Lq1b_91
  s_waitcnt vmcnt(17)
  s_barrier
  s_lshl_b32 s10, s3, 6
  v_add_u32 v42, s10, v0
  v_add_u32 v42, 0, v42
  v_mul_u32_u24 v39, 3641, v42
  v_lshrrev_b32 v39, 16, v39
  v_mul_u32_u24 v43, 18, v39
  v_sub_u32 v42, v42, v43
  v_mul_u32_u24 v39, 9216, v39
  v_lshl_add_u32 v39, v42, 4, v39
  s_lshl_b32 s10, s3, 6
  v_add_u32 v42, s10, v0
  v_add_u32 v42, 256, v42
  v_mul_u32_u24 v40, 3641, v42
  v_lshrrev_b32 v40, 16, v40
  v_mul_u32_u24 v43, 18, v40
  v_sub_u32 v42, v42, v43
  v_mul_u32_u24 v40, 9216, v40
  v_lshl_add_u32 v40, v42, 4, v40
  s_lshl_b32 s10, s3, 6
  v_add_u32 v42, s10, v0
  v_add_u32 v42, 512, v42
  v_mul_u32_u24 v41, 3641, v42
  v_lshrrev_b32 v41, 16, v41
  v_mul_u32_u24 v43, 18, v41
  v_sub_u32 v42, v42, v43
  v_mul_u32_u24 v41, 9216, v41
  v_lshl_add_u32 v41, v42, 4, v41
  s_mul_i32 s15, s4, 288
  s_add_u32 s10, s15, 294912
  s_lshl_b32 s11, s3, 10
  s_add_u32 m0, s11, 84992
  s_nop 0
  buffer_load_dwordx4 v39, s[32:35], s10 offen nt lds
  s_add_u32 m0, s11, 89088
  s_nop 0
  buffer_load_dwordx4 v40, s[32:35], s10 offen nt lds
  s_cmp_eq_u32 s3, 0
  s_cbranch_scc0 Ld9_92
  s_mov_b32 m0, 93184
  s_nop 0
  buffer_load_dwordx4 v41, s[32:35], s10 offen nt lds
Ld9_92:
  s_cmp_eq_u32 s3, 0
  s_cbranch_scc0 Lcb_93
  v_lshrrev_b32 v42, 4, v0
  v_bfe_u32 v43, v0, 2, 2
  v_lshl_add_u32 v42, v42, 3, v43
  v_mul_u32_u24 v44, 288, v42
  v_and_b32 v42, 3, v0
  v_lshl_add_u32 v44, v42, 3, v44
  v_add_u32 v44, 94208, v44
  ds_read_b64_tr_b16 v[208:209], v44 offset:0
  ds_read_b64_tr_b16 v[210:211], v44 offset:1152
  ds_read_b64_tr_b16 v[212:213], v44 offset:32
  ds_read_b64_tr_b16 v[214:215], v44 offset:1184
  ds_read_b64_tr_b16 v[216:217], v44 offset:64
  ds_read_b64_tr_b16 v[218:219], v44 offset:1216
  ds_read_b64_tr_b16 v[220:221], v44 offset:96
  ds_read_b64_tr_b16 v[222:223], v44 offset:1248
  ds_read_b64_tr_b16 v[224:225], v44 offset:128
  ds_read_b64_tr_b16 v[226:227], v44 offset:1280
  ds_read_b64_tr_b16 v[228:229], v44 offset:160
  ds_read_b64_tr_b16 v[230:231], v44 offset:1312
  s_waitcnt lgkmcnt(0)
  ds_read_b64_tr_b16 v[232:233], v44 offset:192
  ds_read_b64_tr_b16 v[234:235], v44 offset:1344
  ds_read_b64_tr_b16 v[236:237], v44 offset:224
  ds_read_b64_tr_b16 v[238:239], v44 offset:1376
  ds_read_b64_tr_b16 v[240:241], v44 offset:256
  ds_read_b64_tr_b16 v[242:243], v44 offset:1408
Lcb_93:
  s_waitcnt lgkmcnt(0)
  s_waitcnt vmcnt(17)
  s_barrier
  s_add_u32 s10, s15, 589824
  s_lshl_b32 s11, s3, 10
  s_add_u32 m0, s11, 94208
  s_nop 0
  buffer_load_dwordx4 v39, s[32:35], s10 offen nt lds
  s_add_u32 m0, s11, 98304
  s_nop 0
  buffer_load_dwordx4 v40, s[32:35], s10 offen nt lds
  s_cmp_eq_u32 s3, 0
  s_cbranch_scc0 Ld9_94
  s_mov_b32 m0, 102400
  s_nop 0
  buffer_load_dwordx4 v41, s[32:35], s10 offen nt lds
Ld9_94:
  s_cmp_eq_u32 s3, 1
  s_cbranch_scc0 Lcb_95
  v_lshrrev_b32 v42, 4, v0
  v_bfe_u32 v43, v0, 2, 2
  v_lshl_add_u32 v42, v42, 3, v43
  v_mul_u32_u24 v44, 288, v42
  v_and_b32 v42, 3, v0
  v_lshl_add_u32 v44, v42, 3, v44
  v_add_u32 v44, 103424, v44
  ds_read_b64_tr_b16 v[208:209], v44 offset:0
  ds_read_b64_tr_b16 v[210:211], v44 offset:1152
  ds_read_b64_tr_b16 v[212:213], v44 offset:32
  ds_read_b64_tr_b16 v[214:215], v44 offset:1184
  ds_read_b64_tr_b16 v[216:217], v44 offset:64
  ds_read_b64_tr_b16 v[218:219], v44 offset:1216
  ds_read_b64_tr_b16 v[220:221], v44 offset:96
  ds_read_b64_tr_b16 v[222:223], v44 offset:1248
  ds_read_b64_tr_b16 v[224:225], v44 offset:128
  ds_read_b64_tr_b16 v[226:227], v44 offset:1280
  ds_read_b64_tr_b16 v[228:229], v44 offset:160
  ds_read_b64_tr_b16 v[230:231], v44 offset:1312
  s_waitcnt lgkmcnt(0)
  ds_read_b64_tr_b16 v[232:233], v44 offset:192
  ds_read_b64_tr_b16 v[234:235], v44 offset:1344
  ds_read_b64_tr_b16 v[236:237], v44 offset:224
  ds_read_b64_tr_b16 v[238:239], v44 offset:1376
  ds_read_b64_tr_b16 v[240:241], v44 offset:256
  ds_read_b64_tr_b16 v[242:243], v44 offset:1408
Lcb_95:
  s_waitcnt lgkmcnt(0)
  s_waitcnt vmcnt(17)
  s_barrier
  s_add_u32 s10, s15, 884736
  s_lshl_b32 s11, s3, 10
  s_add_u32 m0, s11, 103424
  s_nop 0
  buffer_load_dwordx4 v39, s[32:35], s10 offen nt lds
  s_add_u32 m0, s11, 107520
  s_nop 0
  buffer_load_dwordx4 v40, s[32:35], s10 offen nt lds
  s_cmp_eq_u32 s3, 0
  s_cbranch_scc0 Ld9_96
  s_mov_b32 m0, 111616
  s_nop 0
  buffer_load_dwordx4 v41, s[32:35], s10 offen nt lds
Ld9_96:
  s_cmp_eq_u32 s3, 2
  s_cbranch_scc0 Lcb_97
  v_lshrrev_b32 v42, 4, v0
  v_bfe_u32 v43, v0, 2, 2
  v_lshl_add_u32 v42, v42, 3, v43
  v_mul_u32_u24 v44, 288, v42
  v_and_b32 v42, 3, v0
  v_lshl_add_u32 v44, v42, 3, v44
  v_add_u32 v44, 114688, v44
  ds_read_b64_tr_b16 v[208:209], v44 offset:0
  ds_read_b64_tr_b16 v[210:211], v44 offset:1152
  ds_read_b64_tr_b16 v[212:213], v44 offset:32
  ds_read_b64_tr_b16 v[214:215], v44 offset:1184
  ds_read_b64_tr_b16 v[216:217], v44 offset:64
  ds_read_b64_tr_b16 v[218:219], v44 offset:1216
  ds_read_b64_tr_b16 v[220:221], v44 offset:96
  ds_read_b64_tr_b16 v[222:223], v44 offset:1248
  ds_read_b64_tr_b16 v[224:225], v44 offset:128
  ds_read_b64_tr_b16 v[226:227], v44 offset:1280
  ds_read_b64_tr_b16 v[228:229], v44 offset:160
  ds_read_b64_tr_b16 v[230:231], v44 offset:1312
  s_waitcnt lgkmcnt(0)
  ds_read_b64_tr_b16 v[232:233], v44 offset:192
  ds_read_b64_tr_b16 v[234:235], v44 offset:1344
  ds_read_b64_tr_b16 v[236:237], v44 offset:224
  ds_read_b64_tr_b16 v[238:239], v44 offset:1376
  ds_read_b64_tr_b16 v[240:241], v44 offset:256
  ds_read_b64_tr_b16 v[242:243], v44 offset:1408
Lcb_97:
  s_waitcnt lgkmcnt(0)
  s_waitcnt vmcnt(17)
  s_barrier
  s_add_u32 s10, s15, 1179648
  s_lshl_b32 s11, s3, 10
  s_add_u32 m0, s11, 114688
  s_nop 0
  buffer_load_dwordx4 v39, s[32:35], s10 offen nt lds
  s_add_u32 m0, s11, 118784
  s_nop 0
  buffer_load_dwordx4 v40, s[32:35], s10 offen nt lds
  s_cmp_eq_u32 s3, 0
  s_cbranch_scc0 Ld9_98
  s_mov_b32 m0, 122880
  s_nop 0
  buffer_load_dwordx4 v41, s[32:35], s10 offen nt lds
Ld9_98:
  s_cmp_eq_u32 s3, 3
  s_cbranch_scc0 Lcb_99
  v_lshrrev_b32 v42, 4, v0
  v_bfe_u32 v43, v0, 2, 2
  v_lshl_add_u32 v42, v42, 3, v43
  v_mul_u32_u24 v44, 288, v42
  v_and_b32 v42, 3, v0
  v_lshl_add_u32 v44, v42, 3, v44
  v_add_u32 v44, 123904, v44
  ds_read_b64_tr_b16 v[208:209], v44 offset:0
  ds_read_b64_tr_b16 v[210:211], v44 offset:1152
  ds_read_b64_tr_b16 v[212:213], v44 offset:32
  ds_read_b64_tr_b16 v[214:215], v44 offset:1184
  ds_read_b64_tr_b16 v[216:217], v44 offset:64
  ds_read_b64_tr_b16 v[218:219], v44 offset:1216
  ds_read_b64_tr_b16 v[220:221], v44 offset:96
  ds_read_b64_tr_b16 v[222:223], v44 offset:1248
  ds_read_b64_tr_b16 v[224:225], v44 offset:128
  ds_read_b64_tr_b16 v[226:227], v44 offset:1280
  ds_read_b64_tr_b16 v[228:229], v44 offset:160
  ds_read_b64_tr_b16 v[230:231], v44 offset:1312
  s_waitcnt lgkmcnt(0)
  ds_read_b64_tr_b16 v[232:233], v44 offset:192
  ds_read_b64_tr_b16 v[234:235], v44 offset:1344
  ds_read_b64_tr_b16 v[236:237], v44 offset:224
  ds_read_b64_tr_b16 v[238:239], v44 offset:1376
  ds_read_b64_tr_b16 v[240:241], v44 offset:256
  ds_read_b64_tr_b16 v[242:243], v44 offset:1408
Lcb_99:
  s_waitcnt lgkmcnt(0)
  s_branch L_q1
Lq1b_91:
  s_cmp_eq_u32 s7, 2
  s_cbranch_scc0 L_citer
  s_waitcnt vmcnt(18)
  s_barrier
  s_lshl_b32 s10, s3, 6
  v_add_u32 v42, s10, v0
  v_add_u32 v42, 0, v42
  v_mul_u32_u24 v39, 3641, v42
  v_lshrrev_b32 v39, 16, v39
  v_mul_u32_u24 v43, 18, v39
  v_sub_u32 v42, v42, v43
  v_mul_u32_u24 v39, 9216, v39
  v_lshl_add_u32 v39, v42, 4, v39
  s_lshl_b32 s10, s3, 6
  v_add_u32 v42, s10, v0
  v_add_u32 v42, 256, v42
  v_mul_u32_u24 v40, 3641, v42
  v_lshrrev_b32 v40, 16, v40
  v_mul_u32_u24 v43, 18, v40
  v_sub_u32 v42, v42, v43
  v_mul_u32_u24 v40, 9216, v40
  v_lshl_add_u32 v40, v42, 4, v40
  s_lshl_b32 s10, s3, 6
  v_add_u32 v42, s10, v0
  v_add_u32 v42, 512, v42
  v_mul_u32_u24 v41, 3641, v42
  v_lshrrev_b32 v41, 16, v41
  v_mul_u32_u24 v43, 18, v41
  v_sub_u32 v42, v42, v43
  v_mul_u32_u24 v41, 9216, v41
  v_lshl_add_u32 v41, v42, 4, v41
  s_mul_i32 s15, s4, 288
  s_add_u32 s10, s15, 1474560
  s_lshl_b32 s11, s3, 10
  s_add_u32 m0, s11, 123904
  s_nop 0
  buffer_load_dwordx4 v39, s[32:35], s10 offen nt lds
  s_add_u32 m0, s11, 128000
  s_nop 0
  buffer_load_dwordx4 v40, s[32:35], s10 offen nt lds
  s_cmp_eq_u32 s3, 0
  s_cbranch_scc0 Ld9_100
  s_mov_b32 m0, 132096
  s_nop 0
  buffer_load_dwordx4 v41, s[32:35], s10 offen nt lds
Ld9_100:
  s_cmp_eq_u32 s3, 0
  s_cbranch_scc0 Lcb_101
  v_lshrrev_b32 v42, 4, v0
  v_bfe_u32 v43, v0, 2, 2
  v_lshl_add_u32 v42, v42, 3, v43
  v_mul_u32_u24 v44, 288, v42
  v_and_b32 v42, 3, v0
  v_lshl_add_u32 v44, v42, 3, v44
  v_add_u32 v44, 133120, v44
  ds_read_b64_tr_b16 v[244:245], v44 offset:0
  ds_read_b64_tr_b16 v[246:247], v44 offset:1152
  ds_read_b64_tr_b16 v[248:249], v44 offset:32
  ds_read_b64_tr_b16 v[250:251], v44 offset:1184
  ds_read_b64_tr_b16 v[252:253], v44 offset:64
  ds_read_b64_tr_b16 v[254:255], v44 offset:1216
  ds_read_b64_tr_b16 a[0:1], v44 offset:96
  ds_read_b64_tr_b16 a[2:3], v44 offset:1248
  ds_read_b64_tr_b16 a[4:5], v44 offset:128
  ds_read_b64_tr_b16 a[6:7], v44 offset:1280
  ds_read_b64_tr_b16 a[8:9], v44 offset:160
  ds_read_b64_tr_b16 a[10:11], v44 offset:1312
  s_waitcnt lgkmcnt(0)
  ds_read_b64_tr_b16 a[12:13], v44 offset:192
  ds_read_b64_tr_b16 a[14:15], v44 offset:1344
  ds_read_b64_tr_b16 a[16:17], v44 offset:224
  ds_read_b64_tr_b16 a[18:19], v44 offset:1376
  ds_read_b64_tr_b16 a[20:21], v44 offset:256
  ds_read_b64_tr_b16 a[22:23], v44 offset:1408
Lcb_101:
  s_waitcnt lgkmcnt(0)
  s_waitcnt vmcnt(18)
  s_barrier
  s_cmp_eq_u32 s3, 1
  s_cbranch_scc0 Lcb_102
  v_lshrrev_b32 v42, 4, v0
  v_bfe_u32 v43, v0, 2, 2
  v_lshl_add_u32 v42, v42, 3, v43
  v_mul_u32_u24 v44, 288, v42
  v_and_b32 v42, 3, v0
  v_lshl_add_u32 v44, v42, 3, v44
  v_add_u32 v44, 142336, v44
  ds_read_b64_tr_b16 v[244:245], v44 offset:0
  ds_read_b64_tr_b16 v[246:247], v44 offset:1152
  ds_read_b64_tr_b16 v[248:249], v44 offset:32
  ds_read_b64_tr_b16 v[250:251], v44 offset:1184
  ds_read_b64_tr_b16 v[252:253], v44 offset:64
  ds_read_b64_tr_b16 v[254:255], v44 offset:1216
  ds_read_b64_tr_b16 a[0:1], v44 offset:96
  ds_read_b64_tr_b16 a[2:3], v44 offset:1248
  ds_read_b64_tr_b16 a[4:5], v44 offset:128
  ds_read_b64_tr_b16 a[6:7], v44 offset:1280
  ds_read_b64_tr_b16 a[8:9], v44 offset:160
  ds_read_b64_tr_b16 a[10:11], v44 offset:1312
  s_waitcnt lgkmcnt(0)
  ds_read_b64_tr_b16 a[12:13], v44 offset:192
  ds_read_b64_tr_b16 a[14:15], v44 offset:1344
  ds_read_b64_tr_b16 a[16:17], v44 offset:224
  ds_read_b64_tr_b16 a[18:19], v44 offset:1376
  ds_read_b64_tr_b16 a[20:21], v44 offset:256
  ds_read_b64_tr_b16 a[22:23], v44 offset:1408
Lcb_102:
  s_waitcnt lgkmcnt(0)
  s_waitcnt vmcnt(16)
  s_barrier
  s_add_u32 s10, s15, 1769472
  s_lshl_b32 s11, s3, 10
  s_add_u32 m0, s11, 142336
  s_nop 0
  buffer_load_dwordx4 v39, s[32:35], s10 offen nt lds
  s_add_u32 m0, s11, 146432
  s_nop 0
  buffer_load_dwordx4 v40, s[32:35], s10 offen nt lds
  s_cmp_eq_u32 s3, 0
  s_cbranch_scc0 Ld9_103
  s_mov_b32 m0, 150528
  s_nop 0
  buffer_load_dwordx4 v41, s[32:35], s10 offen nt lds
Ld9_103:
  s_cmp_eq_u32 s3, 2
  s_cbranch_scc0 Lcb_104
  v_lshrrev_b32 v42, 4, v0
  v_bfe_u32 v43, v0, 2, 2
  v_lshl_add_u32 v42, v42, 3, v43
  v_mul_u32_u24 v44, 288, v42
  v_and_b32 v42, 3, v0
  v_lshl_add_u32 v44, v42, 3, v44
  v_add_u32 v44, 57344, v44
  ds_read_b64_tr_b16 v[244:245], v44 offset:0
  ds_read_b64_tr_b16 v[246:247], v44 offset:1152
  ds_read_b64_tr_b16 v[248:249], v44 offset:32
  ds_read_b64_tr_b16 v[250:251], v44 offset:1184
  ds_read_b64_tr_b16 v[252:253], v44 offset:64
  ds_read_b64_tr_b16 v[254:255], v44 offset:1216
  ds_read_b64_tr_b16 a[0:1], v44 offset:96
  ds_read_b64_tr_b16 a[2:3], v44 offset:1248
  ds_read_b64_tr_b16 a[4:5], v44 offset:128
  ds_read_b64_tr_b16 a[6:7], v44 offset:1280
  ds_read_b64_tr_b16 a[8:9], v44 offset:160
  ds_read_b64_tr_b16 a[10:11], v44 offset:1312
  s_waitcnt lgkmcnt(0)
  ds_read_b64_tr_b16 a[12:13], v44 offset:192
  ds_read_b64_tr_b16 a[14:15], v44 offset:1344
  ds_read_b64_tr_b16 a[16:17], v44 offset:224
  ds_read_b64_tr_b16 a[18:19], v44 offset:1376
  ds_read_b64_tr_b16 a[20:21], v44 offset:256
  ds_read_b64_tr_b16 a[22:23], v44 offset:1408
Lcb_104:
  s_waitcnt lgkmcnt(0)
  s_waitcnt vmcnt(16)
  s_barrier
  s_add_u32 s10, s15, 2064384
  s_lshl_b32 s11, s3, 10
  s_add_u32 m0, s11, 57344
  s_nop 0
  buffer_load_dwordx4 v39, s[32:35], s10 offen nt lds
  s_add_u32 m0, s11, 61440
  s_nop 0
  buffer_load_dwordx4 v40, s[32:35], s10 offen nt lds
  s_cmp_eq_u32 s3, 0
  s_cbranch_scc0 Ld9_105
  s_mov_b32 m0, 65536
  s_nop 0
  buffer_load_dwordx4 v41, s[32:35], s10 offen nt lds
Ld9_105:
  s_cmp_eq_u32 s3, 3
  s_cbranch_scc0 Lcb_106
  v_lshrrev_b32 v42, 4, v0
  v_bfe_u32 v43, v0, 2, 2
  v_lshl_add_u32 v42, v42, 3, v43
  v_mul_u32_u24 v44, 288, v42
  v_and_b32 v42, 3, v0
  v_lshl_add_u32 v44, v42, 3, v44
  v_add_u32 v44, 66560, v44
  ds_read_b64_tr_b16 v[244:245], v44 offset:0
  ds_read_b64_tr_b16 v[246:247], v44 offset:1152
  ds_read_b64_tr_b16 v[248:249], v44 offset:32
  ds_read_b64_tr_b16 v[250:251], v44 offset:1184
  ds_read_b64_tr_b16 v[252:253], v44 offset:64
  ds_read_b64_tr_b16 v[254:255], v44 offset:1216
  ds_read_b64_tr_b16 a[0:1], v44 offset:96
  ds_read_b64_tr_b16 a[2:3], v44 offset:1248
  ds_read_b64_tr_b16 a[4:5], v44 offset:128
  ds_read_b64_tr_b16 a[6:7], v44 offset:1280
  ds_read_b64_tr_b16 a[8:9], v44 offset:160
  ds_read_b64_tr_b16 a[10:11], v44 offset:1312
  s_waitcnt lgkmcnt(0)
  ds_read_b64_tr_b16 a[12:13], v44 offset:192
  ds_read_b64_tr_b16 a[14:15], v44 offset:1344
  ds_read_b64_tr_b16 a[16:17], v44 offset:224
  ds_read_b64_tr_b16 a[18:19], v44 offset:1376
  ds_read_b64_tr_b16 a[20:21], v44 offset:256
  ds_read_b64_tr_b16 a[22:23], v44 offset:1408
Lcb_106:
  s_waitcnt lgkmcnt(0)
  s_waitcnt vmcnt(16)
  s_barrier
  s_add_u32 s10, s15, 2359296
  s_lshl_b32 s11, s3, 10
  s_add_u32 m0, s11, 66560
  s_nop 0
  buffer_load_dwordx4 v39, s[32:35], s10 offen nt lds
  s_add_u32 m0, s11, 70656
  s_nop 0
  buffer_load_dwordx4 v40, s[32:35], s10 offen nt lds
  s_cmp_eq_u32 s3, 0
  s_cbranch_scc0 Ld9_107
  s_mov_b32 m0, 74752
  s_nop 0
  buffer_load_dwordx4 v41, s[32:35], s10 offen nt lds
Ld9_107:
  v_lshrrev_b32 v42, 4, v0
  v_bfe_u32 v43, v0, 2, 2
  v_lshl_add_u32 v42, v42, 3, v43
  v_mul_u32_u24 v44, 288, v42
  v_and_b32 v42, 3, v0
  v_lshl_add_u32 v44, v42, 3, v44
  s_lshl_b32 s10, s3, 6
  s_add_u32 s10, s10, 75776
  v_add_u32 v44, s10, v44
  ds_read_b64_tr_b16 a[24:25], v44 offset:0
  ds_read_b64_tr_b16 a[26:27], v44 offset:1152
  ds_read_b64_tr_b16 a[28:29], v44 offset:32
  ds_read_b64_tr_b16 a[30:31], v44 offset:1184
  s_cmp_eq_u32 s3, 3
  s_cbranch_scc0 Lc8_108
  ds_read_b64_tr_b16 v[12:13], v44 offset:64
  ds_read_b64_tr_b16 v[14:15], v44 offset:1216
  v_lshlrev_b32 v16, 4, v0
  v_add_u32 v16, 133120, v16
  s_waitcnt lgkmcnt(0)
  ds_write_b128 v16, v[12:15]
Lc8_108:
  s_waitcnt lgkmcnt(0)
  s_waitcnt vmcnt(15)
  s_barrier
  s_add_u32 s10, s15, 2654208
  s_lshl_b32 s11, s3, 10
  s_add_u32 m0, s11, 75776
  s_nop 0
  buffer_load_dwordx4 v39, s[32:35], s10 offen nt lds
  s_add_u32 m0, s11, 79872
  s_nop 0
  buffer_load_dwordx4 v40, s[32:35], s10 offen nt lds
  s_cmp_eq_u32 s3, 0
  s_cbranch_scc0 Ld9_109
  s_mov_b32 m0, 83968
  s_nop 0
  buffer_load_dwordx4 v41, s[32:35], s10 offen nt lds
Ld9_109:
  v_lshrrev_b32 v42, 4, v0
  v_bfe_u32 v43, v0, 2, 2
  v_lshl_add_u32 v42, v42, 3, v43
  v_mul_u32_u24 v44, 288, v42
  v_and_b32 v42, 3, v0
  v_lshl_add_u32 v44, v42, 3, v44
  s_lshl_b32 s10, s3, 6
  s_add_u32 s10, s10, 84992
  v_add_u32 v44, s10, v44
  ds_read_b64_tr_b16 a[32:33], v44 offset:0
  ds_read_b64_tr_b16 a[34:35], v44 offset:1152
  ds_read_b64_tr_b16 a[36:37], v44 offset:32
  ds_read_b64_tr_b16 a[38:39], v44 offset:1184
  s_cmp_eq_u32 s3, 3
  s_cbranch_scc0 Lc8_110
  ds_read_b64_tr_b16 v[12:13], v44 offset:64
  ds_read_b64_tr_b16 v[14:15], v44 offset:1216
  v_lshlrev_b32 v16, 4, v0
  v_add_u32 v16, 134144, v16
  s_waitcnt lgkmcnt(0)
  ds_write_b128 v16, v[12:15]
Lc8_110:
  s_waitcnt lgkmcnt(0)
  s_waitcnt vmcnt(15)
  s_barrier
  s_add_u32 s10, s15, 2949120
  s_lshl_b32 s11, s3, 10
  s_add_u32 m0, s11, 84992
  s_nop 0
  buffer_load_dwordx4 v39, s[32:35], s10 offen nt lds
  s_add_u32 m0, s11, 89088
  s_nop 0
  buffer_load_dwordx4 v40, s[32:35], s10 offen nt lds
  s_cmp_eq_u32 s3, 0
  s_cbranch_scc0 Ld9_111
  s_mov_b32 m0, 93184
  s_nop 0
  buffer_load_dwordx4 v41, s[32:35], s10 offen nt lds
Ld9_111:
  v_lshrrev_b32 v42, 4, v0
  v_bfe_u32 v43, v0, 2, 2
  v_lshl_add_u32 v42, v42, 3, v43
  v_mul_u32_u24 v44, 288, v42
  v_and_b32 v42, 3, v0
  v_lshl_add_u32 v44, v42, 3, v44
  s_lshl_b32 s10, s3, 6
  s_add_u32 s10, s10, 94208
  v_add_u32 v44, s10, v44
  ds_read_b64_tr_b16 a[40:41], v44 offset:0
  ds_read_b64_tr_b16 a[42:43], v44 offset:1152
  ds_read_b64_tr_b16 a[44:45], v44 offset:32
  ds_read_b64_tr_b16 a[46:47], v44 offset:1184
  s_cmp_eq_u32 s3, 3
  s_cbranch_scc0 Lc8_112
  ds_read_b64_tr_b16 v[12:13], v44 offset:64
  ds_read_b64_tr_b16 v[14:15], v44 offset:1216
  v_lshlrev_b32 v16, 4, v0
  v_add_u32 v16, 135168, v16
  s_waitcnt lgkmcnt(0)
  ds_write_b128 v16, v[12:15]
Lc8_112:
  s_waitcnt lgkmcnt(0)
  s_waitcnt vmcnt(15)
  s_barrier
  s_add_u32 s10, s15, 3244032
  s_lshl_b32 s11, s3, 10
  s_add_u32 m0, s11, 94208
  s_nop 0
  buffer_load_dwordx4 v39, s[32:35], s10 offen nt lds
  s_add_u32 m0, s11, 98304
  s_nop 0
  buffer_load_dwordx4 v40, s[32:35], s10 offen nt lds
  s_cmp_eq_u32 s3, 0
  s_cbranch_scc0 Ld9_113
  s_mov_b32 m0, 102400
  s_nop 0
  buffer_load_dwordx4 v41, s[32:35], s10 offen nt lds
Ld9_113:
  v_lshrrev_b32 v42, 4, v0
  v_bfe_u32 v43, v0, 2, 2
  v_lshl_add_u32 v42, v42, 3, v43
  v_mul_u32_u24 v44, 288, v42
  v_and_b32 v42, 3, v0
  v_lshl_add_u32 v44, v42, 3, v44
  s_lshl_b32 s10, s3, 6
  s_add_u32 s10, s10, 103424
  v_add_u32 v44, s10, v44
  ds_read_b64_tr_b16 a[48:49], v44 offset:0
  ds_read_b64_tr_b16 a[50:51], v44 offset:1152
  ds_read_b64_tr_b16 a[52:53], v44 offset:32
  ds_read_b64_tr_b16 a[54:55], v44 offset:1184
  s_cmp_eq_u32 s3, 3
  s_cbranch_scc0 Lc8_114
  ds_read_b64_tr_b16 v[12:13], v44 offset:64
  ds_read_b64_tr_b16 v[14:15], v44 offset:1216
  v_lshlrev_b32 v16, 4, v0
  v_add_u32 v16, 136192, v16
  s_waitcnt lgkmcnt(0)
  ds_write_b128 v16, v[12:15]
Lc8_114:
  s_waitcnt lgkmcnt(0)
  s_waitcnt vmcnt(15)
  s_barrier
  s_add_u32 s10, s15, 3538944
  s_lshl_b32 s11, s3, 10
  s_add_u32 m0, s11, 103424
  s_nop 0
  buffer_load_dwordx4 v39, s[32:35], s10 offen nt lds
  s_add_u32 m0, s11, 107520
  s_nop 0
  buffer_load_dwordx4 v40, s[32:35], s10 offen nt lds
  s_cmp_eq_u32 s3, 0
  s_cbranch_scc0 Ld9_115
  s_mov_b32 m0, 111616
  s_nop 0
  buffer_load_dwordx4 v41, s[32:35], s10 offen nt lds
Ld9_115:
  v_lshrrev_b32 v42, 4, v0
  v_bfe_u32 v43, v0, 2, 2
  v_lshl_add_u32 v42, v42, 3, v43
  v_mul_u32_u24 v44, 288, v42
  v_and_b32 v42, 3, v0
  v_lshl_add_u32 v44, v42, 3, v44
  s_lshl_b32 s10, s3, 6
  s_add_u32 s10, s10, 114688
  v_add_u32 v44, s10, v44
  ds_read_b64_tr_b16 a[56:57], v44 offset:0
  ds_read_b64_tr_b16 a[58:59], v44 offset:1152
  ds_read_b64_tr_b16 a[60:61], v44 offset:32
  ds_read_b64_tr_b16 a[62:63], v44 offset:1184
  s_cmp_eq_u32 s3, 3
  s_cbranch_scc0 Lc8_116
  ds_read_b64_tr_b16 v[12:13], v44 offset:64
  ds_read_b64_tr_b16 v[14:15], v44 offset:1216
  v_lshlrev_b32 v16, 4, v0
  v_add_u32 v16, 137216, v16
  s_waitcnt lgkmcnt(0)
  ds_write_b128 v16, v[12:15]
Lc8_116:
  s_waitcnt lgkmcnt(0)
  s_waitcnt vmcnt(14)
  s_barrier
  s_add_u32 s10, s15, 3833856
  s_lshl_b32 s11, s3, 10
  s_add_u32 m0, s11, 114688
  s_nop 0
  buffer_load_dwordx4 v39, s[32:35], s10 offen nt lds
  s_add_u32 m0, s11, 118784
  s_nop 0
  buffer_load_dwordx4 v40, s[32:35], s10 offen nt lds
  s_cmp_eq_u32 s3, 0
  s_cbranch_scc0 Ld9_117
  s_mov_b32 m0, 122880
  s_nop 0
  buffer_load_dwordx4 v41, s[32:35], s10 offen nt lds
Ld9_117:
  v_lshrrev_b32 v42, 4, v0
  v_bfe_u32 v43, v0, 2, 2
  v_lshl_add_u32 v42, v42, 3, v43
  v_mul_u32_u24 v44, 288, v42
  v_and_b32 v42, 3, v0
  v_lshl_add_u32 v44, v42, 3, v44
  s_lshl_b32 s10, s3, 6
  s_add_u32 s10, s10, 123904
  v_add_u32 v44, s10, v44
  ds_read_b64_tr_b16 a[64:65], v44 offset:0
  ds_read_b64_tr_b16 a[66:67], v44 offset:1152
  ds_read_b64_tr_b16 a[68:69], v44 offset:32
  ds_read_b64_tr_b16 a[70:71], v44 offset:1184
  s_cmp_eq_u32 s3, 3
  s_cbranch_scc0 Lc8_118
  ds_read_b64_tr_b16 v[12:13], v44 offset:64
  ds_read_b64_tr_b16 v[14:15], v44 offset:1216
  v_lshlrev_b32 v16, 4, v0
  v_add_u32 v16, 138240, v16
  s_waitcnt lgkmcnt(0)
  ds_write_b128 v16, v[12:15]
Lc8_118:
  s_waitcnt lgkmcnt(0)
  s_waitcnt vmcnt(14)
  s_barrier
  s_add_u32 s10, s15, 4128768
  s_lshl_b32 s11, s3, 10
  s_add_u32 m0, s11, 123904
  s_nop 0
  buffer_load_dwordx4 v39, s[32:35], s10 offen nt lds
  s_add_u32 m0, s11, 128000
  s_nop 0
  buffer_load_dwordx4 v40, s[32:35], s10 offen nt lds
  s_cmp_eq_u32 s3, 0
  s_cbranch_scc0 Ld9_119
  s_mov_b32 m0, 132096
  s_nop 0
  buffer_load_dwordx4 v41, s[32:35], s10 offen nt lds
Ld9_119:
  v_lshrrev_b32 v42, 4, v0
  v_bfe_u32 v43, v0, 2, 2
  v_lshl_add_u32 v42, v42, 3, v43
  v_mul_u32_u24 v44, 288, v42
  v_and_b32 v42, 3, v0
  v_lshl_add_u32 v44, v42, 3, v44
  s_lshl_b32 s10, s3, 6
  s_add_u32 s10, s10, 142336
  v_add_u32 v44, s10, v44
  ds_read_b64_tr_b16 a[72:73], v44 offset:0
  ds_read_b64_tr_b16 a[74:75], v44 offset:1152
  ds_read_b64_tr_b16 a[76:77], v44 offset:32
  ds_read_b64_tr_b16 a[78:79], v44 offset:1184
  s_cmp_eq_u32 s3, 3
  s_cbranch_scc0 Lc8_120
  ds_read_b64_tr_b16 v[12:13], v44 offset:64
  ds_read_b64_tr_b16 v[14:15], v44 offset:1216
  v_lshlrev_b32 v16, 4, v0
  v_add_u32 v16, 139264, v16
  s_waitcnt lgkmcnt(0)
  ds_write_b128 v16, v[12:15]
Lc8_120:
  s_waitcnt lgkmcnt(0)
  s_waitcnt vmcnt(14)
  s_barrier
  v_lshrrev_b32 v42, 4, v0
  v_bfe_u32 v43, v0, 2, 2
  v_lshl_add_u32 v42, v42, 3, v43
  v_mul_u32_u24 v44, 288, v42
  v_and_b32 v42, 3, v0
  v_lshl_add_u32 v44, v42, 3, v44
  s_lshl_b32 s10, s3, 6
  s_add_u32 s10, s10, 57344
  v_add_u32 v44, s10, v44
  ds_read_b64_tr_b16 a[80:81], v44 offset:0
  ds_read_b64_tr_b16 a[82:83], v44 offset:1152
  ds_read_b64_tr_b16 a[84:85], v44 offset:32
  ds_read_b64_tr_b16 a[86:87], v44 offset:1184
  s_cmp_eq_u32 s3, 3
  s_cbranch_scc0 Lc8_121
  ds_read_b64_tr_b16 v[12:13], v44 offset:64
  ds_read_b64_tr_b16 v[14:15], v44 offset:1216
  v_lshlrev_b32 v16, 4, v0
  v_add_u32 v16, 140288, v16
  s_waitcnt lgkmcnt(0)
  ds_write_b128 v16, v[12:15]
Lc8_121:
  s_waitcnt lgkmcnt(0)
  s_waitcnt vmcnt(12)
  s_barrier
  s_add_u32 s10, s15, 4423680
  s_lshl_b32 s11, s3, 10
  s_add_u32 m0, s11, 57344
  s_nop 0
  buffer_load_dwordx4 v39, s[32:35], s10 offen nt lds
  s_add_u32 m0, s11, 61440
  s_nop 0
  buffer_load_dwordx4 v40, s[32:35], s10 offen nt lds
  s_cmp_eq_u32 s3, 0
  s_cbranch_scc0 Ld9_122
  s_mov_b32 m0, 65536
  s_nop 0
  buffer_load_dwordx4 v41, s[32:35], s10 offen nt lds
Ld9_122:
  v_lshrrev_b32 v42, 4, v0
  v_bfe_u32 v43, v0, 2, 2
  v_lshl_add_u32 v42, v42, 3, v43
  v_mul_u32_u24 v44, 288, v42
  v_and_b32 v42, 3, v0
  v_lshl_add_u32 v44, v42, 3, v44
  s_lshl_b32 s10, s3, 6
  s_add_u32 s10, s10, 66560
  v_add_u32 v44, s10, v44
  ds_read_b64_tr_b16 a[88:89], v44 offset:0
  ds_read_b64_tr_b16 a[90:91], v44 offset:1152
  ds_read_b64_tr_b16 a[92:93], v44 offset:32
  ds_read_b64_tr_b16 a[94:95], v44 offset:1184
  s_cmp_eq_u32 s3, 3
  s_cbranch_scc0 Lc8_123
  ds_read_b64_tr_b16 v[12:13], v44 offset:64
  ds_read_b64_tr_b16 v[14:15], v44 offset:1216
  v_lshlrev_b32 v16, 4, v0
  v_add_u32 v16, 141312, v16
  s_waitcnt lgkmcnt(0)
  ds_write_b128 v16, v[12:15]
Lc8_123:
  s_waitcnt lgkmcnt(0)
  s_waitcnt vmcnt(12)
  s_barrier
  s_add_u32 s10, s15, 4718592
  s_lshl_b32 s11, s3, 10
  s_add_u32 m0, s11, 66560
  s_nop 0
  buffer_load_dwordx4 v39, s[32:35], s10 offen nt lds
  s_add_u32 m0, s11, 70656
  s_nop 0
  buffer_load_dwordx4 v40, s[32:35], s10 offen nt lds
  s_cmp_eq_u32 s3, 0
  s_cbranch_scc0 Ld9_124
  s_mov_b32 m0, 74752
  s_nop 0
  buffer_load_dwordx4 v41, s[32:35], s10 offen nt lds
Ld9_124:
  v_lshrrev_b32 v42, 4, v0
  v_bfe_u32 v43, v0, 2, 2
  v_lshl_add_u32 v42, v42, 3, v43
  v_mul_u32_u24 v44, 288, v42
  v_and_b32 v42, 3, v0
  v_lshl_add_u32 v44, v42, 3, v44
  s_lshl_b32 s10, s3, 6
  s_add_u32 s10, s10, 75776
  v_add_u32 v44, s10, v44
  ds_read_b64_tr_b16 a[96:97], v44 offset:0
  ds_read_b64_tr_b16 a[98:99], v44 offset:1152
  ds_read_b64_tr_b16 a[100:101], v44 offset:32
  ds_read_b64_tr_b16 a[102:103], v44 offset:1184
  s_cmp_eq_u32 s3, 3
  s_cbranch_scc0 Lc8_125
  ds_read_b64_tr_b16 v[12:13], v44 offset:64
  ds_read_b64_tr_b16 v[14:15], v44 offset:1216
  v_lshlrev_b32 v16, 4, v0
  v_add_u32 v16, 142336, v16
  s_waitcnt lgkmcnt(0)
  ds_write_b128 v16, v[12:15]
Lc8_125:
  s_waitcnt lgkmcnt(0)
  s_waitcnt vmcnt(12)
  s_barrier
  s_add_u32 s10, s15, 5013504
  s_lshl_b32 s11, s3, 10
  s_add_u32 m0, s11, 75776
  s_nop 0
  buffer_load_dwordx4 v39, s[32:35], s10 offen nt lds
  s_add_u32 m0, s11, 79872
  s_nop 0
  buffer_load_dwordx4 v40, s[32:35], s10 offen nt lds
  s_cmp_eq_u32 s3, 0
  s_cbranch_scc0 Ld9_126
  s_mov_b32 m0, 83968
  s_nop 0
  buffer_load_dwordx4 v41, s[32:35], s10 offen nt lds
Ld9_126:
  v_lshrrev_b32 v42, 4, v0
  v_bfe_u32 v43, v0, 2, 2
  v_lshl_add_u32 v42, v42, 3, v43
  v_mul_u32_u24 v44, 288, v42
  v_and_b32 v42, 3, v0
  v_lshl_add_u32 v44, v42, 3, v44
  s_lshl_b32 s10, s3, 6
  s_add_u32 s10, s10, 84992
  v_add_u32 v44, s10, v44
  ds_read_b64_tr_b16 a[104:105], v44 offset:0
  ds_read_b64_tr_b16 a[106:107], v44 offset:1152
  ds_read_b64_tr_b16 a[108:109], v44 offset:32
  ds_read_b64_tr_b16 a[110:111], v44 offset:1184
  s_cmp_eq_u32 s3, 3
  s_cbranch_scc0 Lc8_127
  ds_read_b64_tr_b16 v[12:13], v44 offset:64
  ds_read_b64_tr_b16 v[14:15], v44 offset:1216
  v_lshlrev_b32 v16, 4, v0
  v_add_u32 v16, 143360, v16
  s_waitcnt lgkmcnt(0)
  ds_write_b128 v16, v[12:15]
Lc8_127:
  s_waitcnt lgkmcnt(0)
  s_waitcnt vmcnt(12)
  s_barrier
  s_lshl_b32 s10, s3, 6
  v_add_u32 v42, s10, v0
  v_add_u32 v42, 0, v42
  v_mul_u32_u24 v39, 3641, v42
  v_lshrrev_b32 v39, 16, v39
  v_mul_u32_u24 v43, 18, v39
  v_sub_u32 v42, v42, v43
  v_mul_u32_u24 v39, 1152, v39
  v_lshl_add_u32 v39, v42, 4, v39
  s_lshl_b32 s10, s3, 6
  v_add_u32 v42, s10, v0
  v_add_u32 v42, 256, v42
  v_mul_u32_u24 v40, 3641, v42
  v_lshrrev_b32 v40, 16, v40
  v_mul_u32_u24 v43, 18, v40
  v_sub_u32 v42, v42, v43
  v_mul_u32_u24 v40, 1152, v40
  v_lshl_add_u32 v40, v42, 4, v40
  s_lshl_b32 s10, s3, 6
  v_add_u32 v42, s10, v0
  v_add_u32 v42, 512, v42
  v_mul_u32_u24 v41, 3641, v42
  v_lshrrev_b32 v41, 16, v41
  v_mul_u32_u24 v43, 18, v41
  v_sub_u32 v42, v42, v43
  v_mul_u32_u24 v41, 1152, v41
  v_lshl_add_u32 v41, v42, 4, v41
  s_mul_i32 s15, s5, 663552
  s_mul_i32 s10, s6, 288
  s_add_u32 s15, s15, s10
  s_add_u32 s10, s15, 0
  s_lshl_b32 s11, s3, 10
  s_add_u32 m0, s11, 84992
  s_nop 0
  buffer_load_dwordx4 v39, s[36:39], s10 offen nt lds
  s_add_u32 m0, s11, 89088
  s_nop 0
  buffer_load_dwordx4 v40, s[36:39], s10 offen nt lds
  s_cmp_eq_u32 s3, 0
  s_cbranch_scc0 Ld9_128
  s_mov_b32 m0, 93184
  s_nop 0
  buffer_load_dwordx4 v41, s[36:39], s10 offen nt lds
Ld9_128:
  v_lshrrev_b32 v42, 4, v0
  v_bfe_u32 v43, v0, 2, 2
  v_lshl_add_u32 v42, v42, 3, v43
  v_mul_u32_u24 v44, 288, v42
  v_and_b32 v42, 3, v0
  v_lshl_add_u32 v44, v42, 3, v44
  s_lshl_b32 s10, s3, 6
  s_add_u32 s10, s10, 94208
  v_add_u32 v44, s10, v44
  ds_read_b64_tr_b16 a[112:113], v44 offset:0
  ds_read_b64_tr_b16 a[114:115], v44 offset:1152
  ds_read_b64_tr_b16 a[116:117], v44 offset:32
  ds_read_b64_tr_b16 a[118:119], v44 offset:1184
  s_cmp_eq_u32 s3, 3
  s_cbranch_scc0 Lc8_129
  ds_read_b64_tr_b16 v[12:13], v44 offset:64
  ds_read_b64_tr_b16 v[14:15], v44 offset:1216
  v_lshlrev_b32 v16, 4, v0
  v_add_u32 v16, 144384, v16
  s_waitcnt lgkmcnt(0)
  ds_write_b128 v16, v[12:15]
Lc8_129:
  s_waitcnt lgkmcnt(0)
  s_waitcnt vmcnt(12)
  s_barrier
  s_add_u32 s10, s15, 36864
  s_lshl_b32 s11, s3, 10
  s_add_u32 m0, s11, 94208
  s_nop 0
  buffer_load_dwordx4 v39, s[36:39], s10 offen nt lds
  s_add_u32 m0, s11, 98304
  s_nop 0
  buffer_load_dwordx4 v40, s[36:39], s10 offen nt lds
  s_cmp_eq_u32 s3, 0
  s_cbranch_scc0 Ld9_130
  s_mov_b32 m0, 102400
  s_nop 0
  buffer_load_dwordx4 v41, s[36:39], s10 offen nt lds
Ld9_130:
  v_lshrrev_b32 v42, 4, v0
  v_bfe_u32 v43, v0, 2, 2
  v_lshl_add_u32 v42, v42, 3, v43
  v_mul_u32_u24 v44, 288, v42
  v_and_b32 v42, 3, v0
  v_lshl_add_u32 v44, v42, 3, v44
  s_lshl_b32 s10, s3, 6
  s_add_u32 s10, s10, 103424
  v_add_u32 v44, s10, v44
  ds_read_b64_tr_b16 a[120:121], v44 offset:0
  ds_read_b64_tr_b16 a[122:123], v44 offset:1152
  ds_read_b64_tr_b16 a[124:125], v44 offset:32
  ds_read_b64_tr_b16 a[126:127], v44 offset:1184
  s_cmp_eq_u32 s3, 3
  s_cbranch_scc0 Lc8_131
  ds_read_b64_tr_b16 v[12:13], v44 offset:64
  ds_read_b64_tr_b16 v[14:15], v44 offset:1216
  v_lshlrev_b32 v16, 4, v0
  v_add_u32 v16, 145408, v16
  s_waitcnt lgkmcnt(0)
  ds_write_b128 v16, v[12:15]
Lc8_131:
  s_waitcnt lgkmcnt(0)
  s_waitcnt vmcnt(12)
  s_barrier
  s_add_u32 s10, s15, 73728
  s_lshl_b32 s11, s3, 10
  s_add_u32 m0, s11, 103424
  s_nop 0
  buffer_load_dwordx4 v39, s[36:39], s10 offen nt lds
  s_add_u32 m0, s11, 107520
  s_nop 0
  buffer_load_dwordx4 v40, s[36:39], s10 offen nt lds
  s_cmp_eq_u32 s3, 0
  s_cbranch_scc0 Ld9_132
  s_mov_b32 m0, 111616
  s_nop 0
  buffer_load_dwordx4 v41, s[36:39], s10 offen nt lds
Ld9_132:
  v_lshrrev_b32 v42, 4, v0
  v_bfe_u32 v43, v0, 2, 2
  v_lshl_add_u32 v42, v42, 3, v43
  v_mul_u32_u24 v44, 288, v42
  v_and_b32 v42, 3, v0
  v_lshl_add_u32 v44, v42, 3, v44
  s_lshl_b32 s10, s3, 6
  s_add_u32 s10, s10, 114688
  v_add_u32 v44, s10, v44
  ds_read_b64_tr_b16 a[128:129], v44 offset:0
  ds_read_b64_tr_b16 a[130:131], v44 offset:1152
  ds_read_b64_tr_b16 a[132:133], v44 offset:32
  ds_read_b64_tr_b16 a[134:135], v44 offset:1184
  s_cmp_eq_u32 s3, 3
  s_cbranch_scc0 Lc8_133
  ds_read_b64_tr_b16 v[12:13], v44 offset:64
  ds_read_b64_tr_b16 v[14:15], v44 offset:1216
  v_lshlrev_b32 v16, 4, v0
  v_add_u32 v16, 146432, v16
  s_waitcnt lgkmcnt(0)
  ds_write_b128 v16, v[12:15]
Lc8_133:
  s_waitcnt lgkmcnt(0)
  s_waitcnt vmcnt(12)
  s_barrier
  v_lshrrev_b32 v42, 4, v0
  v_bfe_u32 v43, v0, 2, 2
  v_lshl_add_u32 v42, v42, 3, v43
  v_mul_u32_u24 v44, 288, v42
  v_and_b32 v42, 3, v0
  v_lshl_add_u32 v44, v42, 3, v44
  s_lshl_b32 s10, s3, 6
  s_add_u32 s10, s10, 123904
  v_add_u32 v44, s10, v44
  ds_read_b64_tr_b16 a[136:137], v44 offset:0
  ds_read_b64_tr_b16 a[138:139], v44 offset:1152
  ds_read_b64_tr_b16 a[140:141], v44 offset:32
  ds_read_b64_tr_b16 a[142:143], v44 offset:1184
  s_cmp_eq_u32 s3, 3
  s_cbranch_scc0 Lc8_134
  ds_read_b64_tr_b16 v[12:13], v44 offset:64
  ds_read_b64_tr_b16 v[14:15], v44 offset:1216
  v_lshlrev_b32 v16, 4, v0
  v_add_u32 v16, 147456, v16
  s_waitcnt lgkmcnt(0)
  ds_write_b128 v16, v[12:15]
Lc8_134:
  s_waitcnt lgkmcnt(0)
  s_waitcnt vmcnt(10)
  s_barrier
  s_add_u32 s10, s15, 110592
  s_lshl_b32 s11, s3, 10
  s_add_u32 m0, s11, 123904
  s_nop 0
  buffer_load_dwordx4 v39, s[36:39], s10 offen nt lds
  s_add_u32 m0, s11, 128000
  s_nop 0
  buffer_load_dwordx4 v40, s[36:39], s10 offen nt lds
  s_cmp_eq_u32 s3, 0
  s_cbranch_scc0 Ld9_135
  s_mov_b32 m0, 132096
  s_nop 0
  buffer_load_dwordx4 v41, s[36:39], s10 offen nt lds
Ld9_135:
  v_lshrrev_b32 v42, 4, v0
  v_bfe_u32 v43, v0, 2, 2
  v_lshl_add_u32 v42, v42, 3, v43
  v_mul_u32_u24 v44, 288, v42
  v_and_b32 v42, 3, v0
  v_lshl_add_u32 v44, v42, 3, v44
  s_lshl_b32 s10, s3, 6
  s_add_u32 s10, s10, 57344
  v_add_u32 v44, s10, v44
  ds_read_b64_tr_b16 a[144:145], v44 offset:0
  ds_read_b64_tr_b16 a[146:147], v44 offset:1152
  ds_read_b64_tr_b16 a[148:149], v44 offset:32
  ds_read_b64_tr_b16 a[150:151], v44 offset:1184
  s_cmp_eq_u32 s3, 3
  s_cbranch_scc0 Lc8_136
  ds_read_b64_tr_b16 v[12:13], v44 offset:64
  ds_read_b64_tr_b16 v[14:15], v44 offset:1216
  v_lshlrev_b32 v16, 4, v0
  v_add_u32 v16, 148480, v16
  s_waitcnt lgkmcnt(0)
  ds_write_b128 v16, v[12:15]
Lc8_136:
  s_waitcnt lgkmcnt(0)
  s_waitcnt vmcnt(10)
  s_barrier
  s_add_u32 s10, s15, 147456
  s_lshl_b32 s11, s3, 10
  s_add_u32 m0, s11, 57344
  s_nop 0
  buffer_load_dwordx4 v39, s[36:39], s10 offen nt lds
  s_add_u32 m0, s11, 61440
  s_nop 0
  buffer_load_dwordx4 v40, s[36:39], s10 offen nt lds
  s_cmp_eq_u32 s3, 0
  s_cbranch_scc0 Ld9_137
  s_mov_b32 m0, 65536
  s_nop 0
  buffer_load_dwordx4 v41, s[36:39], s10 offen nt lds
Ld9_137:
  v_lshrrev_b32 v42, 4, v0
  v_bfe_u32 v43, v0, 2, 2
  v_lshl_add_u32 v42, v42, 3, v43
  v_mul_u32_u24 v44, 288, v42
  v_and_b32 v42, 3, v0
  v_lshl_add_u32 v44, v42, 3, v44
  s_lshl_b32 s10, s3, 6
  s_add_u32 s10, s10, 66560
  v_add_u32 v44, s10, v44
  ds_read_b64_tr_b16 a[152:153], v44 offset:0
  ds_read_b64_tr_b16 a[154:155], v44 offset:1152
  ds_read_b64_tr_b16 a[156:157], v44 offset:32
  ds_read_b64_tr_b16 a[158:159], v44 offset:1184
  s_cmp_eq_u32 s3, 3
  s_cbranch_scc0 Lc8_138
  ds_read_b64_tr_b16 v[12:13], v44 offset:64
  ds_read_b64_tr_b16 v[14:15], v44 offset:1216
  v_lshlrev_b32 v16, 4, v0
  v_add_u32 v16, 149504, v16
  s_waitcnt lgkmcnt(0)
  ds_write_b128 v16, v[12:15]
Lc8_138:
  s_waitcnt lgkmcnt(0)
  s_waitcnt vmcnt(10)
  s_barrier
  s_add_u32 s10, s15, 184320
  s_lshl_b32 s11, s3, 10
  s_add_u32 m0, s11, 66560
  s_nop 0
  buffer_load_dwordx4 v39, s[36:39], s10 offen nt lds
  s_add_u32 m0, s11, 70656
  s_nop 0
  buffer_load_dwordx4 v40, s[36:39], s10 offen nt lds
  s_cmp_eq_u32 s3, 0
  s_cbranch_scc0 Ld9_139
  s_mov_b32 m0, 74752
  s_nop 0
  buffer_load_dwordx4 v41, s[36:39], s10 offen nt lds
Ld9_139:
  v_lshrrev_b32 v42, 4, v0
  v_bfe_u32 v43, v0, 2, 2
  v_lshl_add_u32 v42, v42, 3, v43
  v_mul_u32_u24 v44, 288, v42
  v_and_b32 v42, 3, v0
  v_lshl_add_u32 v44, v42, 3, v44
  s_lshl_b32 s10, s3, 6
  s_add_u32 s10, s10, 75776
  v_add_u32 v44, s10, v44
  ds_read_b64_tr_b16 a[160:161], v44 offset:0
  ds_read_b64_tr_b16 a[162:163], v44 offset:1152
  ds_read_b64_tr_b16 a[164:165], v44 offset:32
  ds_read_b64_tr_b16 a[166:167], v44 offset:1184
  s_cmp_eq_u32 s3, 3
  s_cbranch_scc0 Lc8_140
  ds_read_b64_tr_b16 v[12:13], v44 offset:64
  ds_read_b64_tr_b16 v[14:15], v44 offset:1216
  v_lshlrev_b32 v16, 4, v0
  v_add_u32 v16, 150528, v16
  s_waitcnt lgkmcnt(0)
  ds_write_b128 v16, v[12:15]
Lc8_140:
  s_waitcnt lgkmcnt(0)
  s_waitcnt vmcnt(10)
  s_barrier
  s_add_u32 s10, s15, 221184
  s_lshl_b32 s11, s3, 10
  s_add_u32 m0, s11, 75776
  s_nop 0
  buffer_load_dwordx4 v39, s[36:39], s10 offen nt lds
  s_add_u32 m0, s11, 79872
  s_nop 0
  buffer_load_dwordx4 v40, s[36:39], s10 offen nt lds
  s_cmp_eq_u32 s3, 0
  s_cbranch_scc0 Ld9_141
  s_mov_b32 m0, 83968
  s_nop 0
  buffer_load_dwordx4 v41, s[36:39], s10 offen nt lds
Ld9_141:
  v_lshrrev_b32 v42, 4, v0
  v_bfe_u32 v43, v0, 2, 2
  v_lshl_add_u32 v42, v42, 3, v43
  v_mul_u32_u24 v44, 288, v42
  v_and_b32 v42, 3, v0
  v_lshl_add_u32 v44, v42, 3, v44
  s_lshl_b32 s10, s3, 6
  s_add_u32 s10, s10, 84992
  v_add_u32 v44, s10, v44
  ds_read_b64_tr_b16 a[168:169], v44 offset:0
  ds_read_b64_tr_b16 a[170:171], v44 offset:1152
  ds_read_b64_tr_b16 a[172:173], v44 offset:32
  ds_read_b64_tr_b16 a[174:175], v44 offset:1184
  s_cmp_eq_u32 s3, 3
  s_cbranch_scc0 Lc8_142
  ds_read_b64_tr_b16 v[12:13], v44 offset:64
  ds_read_b64_tr_b16 v[14:15], v44 offset:1216
  v_lshlrev_b32 v16, 4, v0
  v_add_u32 v16, 114688, v16
  s_waitcnt lgkmcnt(0)
  ds_write_b128 v16, v[12:15]
Lc8_142:
  s_waitcnt lgkmcnt(0)
  s_waitcnt vmcnt(10)
  s_barrier
  s_add_u32 s10, s15, 258048
  s_lshl_b32 s11, s3, 10
  s_add_u32 m0, s11, 84992
  s_nop 0
  buffer_load_dwordx4 v39, s[36:39], s10 offen nt lds
  s_add_u32 m0, s11, 89088
  s_nop 0
  buffer_load_dwordx4 v40, s[36:39], s10 offen nt lds
  s_cmp_eq_u32 s3, 0
  s_cbranch_scc0 Ld9_143
  s_mov_b32 m0, 93184
  s_nop 0
  buffer_load_dwordx4 v41, s[36:39], s10 offen nt lds
Ld9_143:
  v_lshrrev_b32 v42, 4, v0
  v_bfe_u32 v43, v0, 2, 2
  v_lshl_add_u32 v42, v42, 3, v43
  v_mul_u32_u24 v44, 288, v42
  v_and_b32 v42, 3, v0
  v_lshl_add_u32 v44, v42, 3, v44
  s_lshl_b32 s10, s3, 6
  s_add_u32 s10, s10, 94208
  v_add_u32 v44, s10, v44
  ds_read_b64_tr_b16 a[176:177], v44 offset:0
  ds_read_b64_tr_b16 a[178:179], v44 offset:1152
  ds_read_b64_tr_b16 a[180:181], v44 offset:32
  ds_read_b64_tr_b16 a[182:183], v44 offset:1184
  s_cmp_eq_u32 s3, 3
  s_cbranch_scc0 Lc8_144
  ds_read_b64_tr_b16 v[12:13], v44 offset:64
  ds_read_b64_tr_b16 v[14:15], v44 offset:1216
  v_lshlrev_b32 v16, 4, v0
  v_add_u32 v16, 115712, v16
  s_waitcnt lgkmcnt(0)
  ds_write_b128 v16, v[12:15]
Lc8_144:
  s_waitcnt lgkmcnt(0)
  s_waitcnt vmcnt(10)
  s_barrier
  s_add_u32 s10, s15, 294912
  s_lshl_b32 s11, s3, 10
  s_add_u32 m0, s11, 94208
  s_nop 0
  buffer_load_dwordx4 v39, s[36:39], s10 offen nt lds
  s_add_u32 m0, s11, 98304
  s_nop 0
  buffer_load_dwordx4 v40, s[36:39], s10 offen nt lds
  s_cmp_eq_u32 s3, 0
  s_cbranch_scc0 Ld9_145
  s_mov_b32 m0, 102400
  s_nop 0
  buffer_load_dwordx4 v41, s[36:39], s10 offen nt lds
Ld9_145:
  v_lshrrev_b32 v42, 4, v0
  v_bfe_u32 v43, v0, 2, 2
  v_lshl_add_u32 v42, v42, 3, v43
  v_mul_u32_u24 v44, 288, v42
  v_and_b32 v42, 3, v0
  v_lshl_add_u32 v44, v42, 3, v44
  s_lshl_b32 s10, s3, 6
  s_add_u32 s10, s10, 103424
  v_add_u32 v44, s10, v44
  ds_read_b64_tr_b16 a[184:185], v44 offset:0
  ds_read_b64_tr_b16 a[186:187], v44 offset:1152
  ds_read_b64_tr_b16 a[188:189], v44 offset:32
  ds_read_b64_tr_b16 a[190:191], v44 offset:1184
  s_cmp_eq_u32 s3, 3
  s_cbranch_scc0 Lc8_146
  ds_read_b64_tr_b16 v[12:13], v44 offset:64
  ds_read_b64_tr_b16 v[14:15], v44 offset:1216
  v_lshlrev_b32 v16, 4, v0
  v_add_u32 v16, 116736, v16
  s_waitcnt lgkmcnt(0)
  ds_write_b128 v16, v[12:15]
Lc8_146:
  s_waitcnt lgkmcnt(0)
  s_waitcnt vmcnt(10)
  s_barrier
  s_add_u32 s10, s15, 331776
  s_lshl_b32 s11, s3, 10
  s_add_u32 m0, s11, 103424
  s_nop 0
  buffer_load_dwordx4 v39, s[36:39], s10 offen nt lds
  s_add_u32 m0, s11, 107520
  s_nop 0
  buffer_load_dwordx4 v40, s[36:39], s10 offen nt lds
  s_cmp_eq_u32 s3, 0
  s_cbranch_scc0 Ld9_147
  s_mov_b32 m0, 111616
  s_nop 0
  buffer_load_dwordx4 v41, s[36:39], s10 offen nt lds
Ld9_147:
  v_lshrrev_b32 v42, 4, v0
  v_bfe_u32 v43, v0, 2, 2
  v_lshl_add_u32 v42, v42, 3, v43
  v_mul_u32_u24 v44, 288, v42
  v_and_b32 v42, 3, v0
  v_lshl_add_u32 v44, v42, 3, v44
  s_lshl_b32 s10, s3, 6
  s_add_u32 s10, s10, 123904
  v_add_u32 v44, s10, v44
  ds_read_b64_tr_b16 a[192:193], v44 offset:0
  ds_read_b64_tr_b16 a[194:195], v44 offset:1152
  ds_read_b64_tr_b16 a[196:197], v44 offset:32
  ds_read_b64_tr_b16 a[198:199], v44 offset:1184
  s_cmp_eq_u32 s3, 3
  s_cbranch_scc0 Lc8_148
  ds_read_b64_tr_b16 v[12:13], v44 offset:64
  ds_read_b64_tr_b16 v[14:15], v44 offset:1216
  v_lshlrev_b32 v16, 4, v0
  v_add_u32 v16, 117760, v16
  s_waitcnt lgkmcnt(0)
  ds_write_b128 v16, v[12:15]
Lc8_148:
  s_waitcnt lgkmcnt(0)
  s_waitcnt vmcnt(10)
  s_barrier
  v_lshrrev_b32 v42, 4, v0
  v_bfe_u32 v43, v0, 2, 2
  v_lshl_add_u32 v42, v42, 3, v43
  v_mul_u32_u24 v44, 288, v42
  v_and_b32 v42, 3, v0
  v_lshl_add_u32 v44, v42, 3, v44
  s_lshl_b32 s10, s3, 6
  s_add_u32 s10, s10, 57344
  v_add_u32 v44, s10, v44
  ds_read_b64_tr_b16 a[200:201], v44 offset:0
  ds_read_b64_tr_b16 a[202:203], v44 offset:1152
  ds_read_b64_tr_b16 a[204:205], v44 offset:32
  ds_read_b64_tr_b16 a[206:207], v44 offset:1184
  s_cmp_eq_u32 s3, 3
  s_cbranch_scc0 Lc8_149
  ds_read_b64_tr_b16 v[12:13], v44 offset:64
  ds_read_b64_tr_b16 v[14:15], v44 offset:1216
  v_lshlrev_b32 v16, 4, v0
  v_add_u32 v16, 118784, v16
  s_waitcnt lgkmcnt(0)
  ds_write_b128 v16, v[12:15]
Lc8_149:
  s_waitcnt lgkmcnt(0)
  s_waitcnt vmcnt(8)
  s_barrier
  s_add_u32 s10, s15, 368640
  s_lshl_b32 s11, s3, 10
  s_add_u32 m0, s11, 57344
  s_nop 0
  buffer_load_dwordx4 v39, s[36:39], s10 offen nt lds
  s_add_u32 m0, s11, 61440
  s_nop 0
  buffer_load_dwordx4 v40, s[36:39], s10 offen nt lds
  s_cmp_eq_u32 s3, 0
  s_cbranch_scc0 Ld9_150
  s_mov_b32 m0, 65536
  s_nop 0
  buffer_load_dwordx4 v41, s[36:39], s10 offen nt lds
Ld9_150:
  v_lshrrev_b32 v42, 4, v0
  v_bfe_u32 v43, v0, 2, 2
  v_lshl_add_u32 v42, v42, 3, v43
  v_mul_u32_u24 v44, 288, v42
  v_and_b32 v42, 3, v0
  v_lshl_add_u32 v44, v42, 3, v44
  s_lshl_b32 s10, s3, 6
  s_add_u32 s10, s10, 66560
  v_add_u32 v44, s10, v44
  ds_read_b64_tr_b16 a[208:209], v44 offset:0
  ds_read_b64_tr_b16 a[210:211], v44 offset:1152
  ds_read_b64_tr_b16 a[212:213], v44 offset:32
  ds_read_b64_tr_b16 a[214:215], v44 offset:1184
  s_cmp_eq_u32 s3, 3
  s_cbranch_scc0 Lc8_151
  ds_read_b64_tr_b16 v[12:13], v44 offset:64
  ds_read_b64_tr_b16 v[14:15], v44 offset:1216
  v_lshlrev_b32 v16, 4, v0
  v_add_u32 v16, 119808, v16
  s_waitcnt lgkmcnt(0)
  ds_write_b128 v16, v[12:15]
Lc8_151:
  s_waitcnt lgkmcnt(0)
  s_waitcnt vmcnt(8)
  s_barrier
  v_lshrrev_b32 v42, 4, v0
  v_bfe_u32 v43, v0, 2, 2
  v_lshl_add_u32 v42, v42, 3, v43
  v_mul_u32_u24 v44, 288, v42
  v_and_b32 v42, 3, v0
  v_lshl_add_u32 v44, v42, 3, v44
  s_lshl_b32 s10, s3, 6
  s_add_u32 s10, s10, 75776
  v_add_u32 v44, s10, v44
  ds_read_b64_tr_b16 a[216:217], v44 offset:0
  ds_read_b64_tr_b16 a[218:219], v44 offset:1152
  ds_read_b64_tr_b16 a[220:221], v44 offset:32
  ds_read_b64_tr_b16 a[222:223], v44 offset:1184
  s_cmp_eq_u32 s3, 3
  s_cbranch_scc0 Lc8_152
  ds_read_b64_tr_b16 v[12:13], v44 offset:64
  ds_read_b64_tr_b16 v[14:15], v44 offset:1216
  v_lshlrev_b32 v16, 4, v0
  v_add_u32 v16, 120832, v16
  s_waitcnt lgkmcnt(0)
  ds_write_b128 v16, v[12:15]
Lc8_152:
  s_waitcnt lgkmcnt(0)
  s_waitcnt vmcnt(6)
  s_barrier
  v_lshrrev_b32 v42, 4, v0
  v_bfe_u32 v43, v0, 2, 2
  v_lshl_add_u32 v42, v42, 3, v43
  v_mul_u32_u24 v44, 288, v42
  v_and_b32 v42, 3, v0
  v_lshl_add_u32 v44, v42, 3, v44
  s_lshl_b32 s10, s3, 6
  s_add_u32 s10, s10, 84992
  v_add_u32 v44, s10, v44
  ds_read_b64_tr_b16 a[224:225], v44 offset:0
  ds_read_b64_tr_b16 a[226:227], v44 offset:1152
  ds_read_b64_tr_b16 a[228:229], v44 offset:32
  ds_read_b64_tr_b16 a[230:231], v44 offset:1184
  s_cmp_eq_u32 s3, 3
  s_cbranch_scc0 Lc8_153
  ds_read_b64_tr_b16 v[12:13], v44 offset:64
  ds_read_b64_tr_b16 v[14:15], v44 offset:1216
  v_lshlrev_b32 v16, 4, v0
  v_add_u32 v16, 121856, v16
  s_waitcnt lgkmcnt(0)
  ds_write_b128 v16, v[12:15]
Lc8_153:
  s_waitcnt lgkmcnt(0)
  s_waitcnt vmcnt(4)
  s_barrier
  v_lshrrev_b32 v42, 4, v0
  v_bfe_u32 v43, v0, 2, 2
  v_lshl_add_u32 v42, v42, 3, v43
  v_mul_u32_u24 v44, 288, v42
  v_and_b32 v42, 3, v0
  v_lshl_add_u32 v44, v42, 3, v44
  s_lshl_b32 s10, s3, 6
  s_add_u32 s10, s10, 94208
  v_add_u32 v44, s10, v44
  ds_read_b64_tr_b16 a[232:233], v44 offset:0
  ds_read_b64_tr_b16 a[234:235], v44 offset:1152
  ds_read_b64_tr_b16 a[236:237], v44 offset:32
  ds_read_b64_tr_b16 a[238:239], v44 offset:1184
  s_cmp_eq_u32 s3, 3
  s_cbranch_scc0 Lc8_154
  ds_read_b64_tr_b16 v[12:13], v44 offset:64
  ds_read_b64_tr_b16 v[14:15], v44 offset:1216
  v_lshlrev_b32 v16, 4, v0
  v_add_u32 v16, 122880, v16
  s_waitcnt lgkmcnt(0)
  ds_write_b128 v16, v[12:15]
Lc8_154:
  s_waitcnt lgkmcnt(0)
  s_waitcnt vmcnt(2)
  s_barrier
  v_lshrrev_b32 v42, 4, v0
  v_bfe_u32 v43, v0, 2, 2
  v_lshl_add_u32 v42, v42, 3, v43
  v_mul_u32_u24 v44, 288, v42
  v_and_b32 v42, 3, v0
  v_lshl_add_u32 v44, v42, 3, v44
  s_lshl_b32 s10, s3, 6
  s_add_u32 s10, s10, 103424
  v_add_u32 v44, s10, v44
  ds_read_b64_tr_b16 a[240:241], v44 offset:0
  ds_read_b64_tr_b16 a[242:243], v44 offset:1152
  ds_read_b64_tr_b16 a[244:245], v44 offset:32
  ds_read_b64_tr_b16 a[246:247], v44 offset:1184
  s_cmp_eq_u32 s3, 3
  s_cbranch_scc0 Lc8_155
  ds_read_b64_tr_b16 v[12:13], v44 offset:64
  ds_read_b64_tr_b16 v[14:15], v44 offset:1216
  v_lshlrev_b32 v16, 4, v0
  v_add_u32 v16, 123904, v16
  s_waitcnt lgkmcnt(0)
  ds_write_b128 v16, v[12:15]
Lc8_155:
  s_waitcnt lgkmcnt(0)
  s_waitcnt vmcnt(0)
  s_barrier
  v_lshrrev_b32 v42, 4, v0
  v_bfe_u32 v43, v0, 2, 2
  v_lshl_add_u32 v42, v42, 3, v43
  v_mul_u32_u24 v44, 288, v42
  v_and_b32 v42, 3, v0
  v_lshl_add_u32 v44, v42, 3, v44
  s_lshl_b32 s10, s3, 6
  s_add_u32 s10, s10, 57344
  v_add_u32 v44, s10, v44
  ds_read_b64_tr_b16 a[248:249], v44 offset:0
  ds_read_b64_tr_b16 a[250:251], v44 offset:1152
  ds_read_b64_tr_b16 a[252:253], v44 offset:32
  ds_read_b64_tr_b16 a[254:255], v44 offset:1184
  s_cmp_eq_u32 s3, 3
  s_cbranch_scc0 Lc8_156
  ds_read_b64_tr_b16 v[12:13], v44 offset:64
  ds_read_b64_tr_b16 v[14:15], v44 offset:1216
  v_lshlrev_b32 v16, 4, v0
  v_add_u32 v16, 124928, v16
  s_waitcnt lgkmcnt(0)
  ds_write_b128 v16, v[12:15]
Lc8_156:
  s_waitcnt lgkmcnt(0)
  s_barrier
  v_mov_b32 v15, 128
  v_mov_b32 v19, 0
  buffer_load_dwordx2 v[16:17], v15, s[20:23], 0 offen sc1
  buffer_load_dword v18, v19, s[20:23], 0 offen sc1
  v_lshrrev_b32 v42, 4, v0
  v_mul_u32_u24 v37, 1152, v42
  v_lshlrev_b32 v42, 1, v42
  v_and_b32 v43, 15, v0
  v_xor_b32 v42, v42, v43
  v_lshlrev_b32 v42, 4, v42
  v_add_u32 v36, v37, v42
  v_xor_b32 v42, 128, v42
  v_add_u32 v37, v37, v42
  v_lshrrev_b32 v38, 1, v0
  v_mul_u32_u24 v38, 1152, v38
  v_and_b32 v42, 1, v0
  v_lshl_add_u32 v38, v42, 4, v38
  s_mul_i32 s15, s5, 663552
  s_mul_i32 s10, s6, 288
  s_add_u32 s15, s15, s10
  s_mul_i32 s11, s3, 9216
  s_add_u32 s11, s11, s15
  s_add_u32 m0, s56, 57344
  s_add_u32 s10, s11, 405504
  buffer_load_dwordx4 v36, s[36:39], s10 offen nt lds
  s_add_u32 m0, s56, 58368
  s_add_u32 s10, s11, 410112
  buffer_load_dwordx4 v37, s[36:39], s10 offen nt lds
  s_mul_i32 s11, s3, 9216
  s_add_u32 s11, s11, s15
  s_add_u32 m0, s56, 65536
  s_add_u32 s10, s11, 442368
  buffer_load_dwordx4 v36, s[36:39], s10 offen nt lds
  s_add_u32 m0, s56, 66560
  s_add_u32 s10, s11, 446976
  buffer_load_dwordx4 v37, s[36:39], s10 offen nt lds
  s_mul_i32 s11, s3, 9216
  s_add_u32 s11, s11, s15
  s_add_u32 m0, s56, 73728
  s_add_u32 s10, s11, 479232
  buffer_load_dwordx4 v36, s[36:39], s10 offen nt lds
  s_add_u32 m0, s56, 74752
  s_add_u32 s10, s11, 483840
  buffer_load_dwordx4 v37, s[36:39], s10 offen nt lds
  s_mul_i32 s11, s3, 9216
  s_add_u32 s11, s11, s15
  s_add_u32 m0, s56, 81920
  s_add_u32 s10, s11, 516096
  buffer_load_dwordx4 v36, s[36:39], s10 offen nt lds
  s_add_u32 m0, s56, 82944
  s_add_u32 s10, s11, 520704
  buffer_load_dwordx4 v37, s[36:39], s10 offen nt lds
  s_mul_i32 s11, s3, 9216
  s_add_u32 s11, s11, s15
  s_add_u32 m0, s56, 90112
  s_add_u32 s10, s11, 552960
  buffer_load_dwordx4 v36, s[36:39], s10 offen nt lds
  s_add_u32 m0, s56, 91136
  s_add_u32 s10, s11, 557568
  buffer_load_dwordx4 v37, s[36:39], s10 offen nt lds
  s_mul_i32 s11, s3, 9216
  s_add_u32 s11, s11, s15
  s_add_u32 m0, s56, 98304
  s_add_u32 s10, s11, 589824
  buffer_load_dwordx4 v36, s[36:39], s10 offen nt lds
  s_add_u32 m0, s56, 99328
  s_add_u32 s10, s11, 594432
  buffer_load_dwordx4 v37, s[36:39], s10 offen nt lds
  s_mul_i32 s11, s3, 9216
  s_add_u32 s11, s11, s15
  s_add_u32 m0, s56, 106496
  s_add_u32 s10, s11, 626688
  buffer_load_dwordx4 v36, s[36:39], s10 offen nt lds
  s_add_u32 m0, s56, 107520
  s_add_u32 s10, s11, 631296
  buffer_load_dwordx4 v37, s[36:39], s10 offen nt lds
  s_cmp_eq_u32 s3, 3
  s_cbranch_scc0 Lo3_157
  s_mov_b32 m0, 125952
  s_add_u32 s10, s15, 405760
  buffer_load_dwordx4 v38, s[36:39], s10 offen nt lds
  s_mov_b32 m0, 126976
  s_add_u32 s10, s15, 442624
  buffer_load_dwordx4 v38, s[36:39], s10 offen nt lds
  s_mov_b32 m0, 128000
  s_add_u32 s10, s15, 479488
  buffer_load_dwordx4 v38, s[36:39], s10 offen nt lds
  s_mov_b32 m0, 129024
  s_add_u32 s10, s15, 516352
  buffer_load_dwordx4 v38, s[36:39], s10 offen nt lds
  s_mov_b32 m0, 130048
  s_add_u32 s10, s15, 553216
  buffer_load_dwordx4 v38, s[36:39], s10 offen nt lds
  s_mov_b32 m0, 131072
  s_add_u32 s10, s15, 590080
  buffer_load_dwordx4 v38, s[36:39], s10 offen nt lds
  s_mov_b32 m0, 132096
  s_add_u32 s10, s15, 626944
  buffer_load_dwordx4 v38, s[36:39], s10 offen nt lds
Lo3_157:
  s_waitcnt vmcnt(14)
  s_mov_b32 s13, 0
Lcs_158:
  v_sad_u8 v20, v16, 0, 0
  v_sad_u8 v20, v17, 0, v20
  s_nop 0
  v_readfirstlane_b32 s10, v20
  v_readfirstlane_b32 s11, v18
  s_cmp_ge_u32 s10, 32
  s_cselect_b32 s10, 1, 0
  s_cmp_ge_u32 s11, 224
  s_cselect_b32 s10, s10, 0
  s_cmp_eq_u32 s10, 1
  s_cbranch_scc1 Lco_159
  buffer_load_dwordx2 v[16:17], v15, s[20:23], 0 offen sc1
  buffer_load_dword v18, v19, s[20:23], 0 offen sc1
  s_waitcnt vmcnt(0)
  s_add_u32 s13, s13, 1
  s_cmp_lt_u32 s13, 20000
  s_cbranch_scc1 Lcs_158
Lco_159:
  v_readfirstlane_b32 s10, v16
  v_readfirstlane_b32 s11, v17
  s_nop 0
  s_or_b32 s12, s10, s11
  s_mov_b32 s9, 0
  s_cmp_eq_u32 s12, 0x20
  s_cselect_b32 s9, 1, s9
  s_cmp_eq_u32 s12, 0x2000
  s_cselect_b32 s9, 1, s9
  s_cmp_eq_u32 s12, 0x200000
  s_cselect_b32 s9, 1, s9
  s_cmp_eq_u32 s12, 0x20000000
  s_cselect_b32 s9, 1, s9
  s_min_u32 s10, s10, s11
  s_cmp_eq_u32 s10, 0
  s_cselect_b32 s9, s9, 0
  v_mov_b32 v12, 0x3f803f80
  v_mov_b32 v13, 0x3f803f80
  v_lshrrev_b32 v14, 1, v1
  v_add_u32 v14, 151552, v14
  s_mov_b32 exec_lo, -1
  s_mov_b32 exec_hi, 0xf
  ds_write_b64 v14, v[12:13]
  s_mov_b64 exec, -1
  s_waitcnt lgkmcnt(0)
  s_barrier
  ds_read_b128 v[20:23], v2 offset:0
  ds_read_b128 v[24:27], v2 offset:64
  ds_read_b128 v[28:31], v2 offset:128
  ds_read_b128 v[32:35], v2 offset:192
  s_waitcnt lgkmcnt(3)
  v_mfma_f32_16x16x32_bf16 v[12:15], v[20:23], a[24:27], 0
  v_mfma_f32_16x16x32_bf16 v[16:19], v[20:23], a[28:31], 0
  ds_read_b128 v[20:23], v2 offset:256
  s_waitcnt lgkmcnt(3)
  v_mfma_f32_16x16x32_bf16 v[12:15], v[24:27], a[32:35], v[12:15]
  v_mfma_f32_16x16x32_bf16 v[16:19], v[24:27], a[36:39], v[16:19]
  ds_read_b128 v[24:27], v2 offset:320
  s_waitcnt lgkmcnt(3)
  v_mfma_f32_16x16x32_bf16 v[12:15], v[28:31], a[40:43], v[12:15]
  v_mfma_f32_16x16x32_bf16 v[16:19], v[28:31], a[44:47], v[16:19]
  ds_read_b128 v[28:31], v2 offset:384
  s_waitcnt lgkmcnt(3)
  v_mfma_f32_16x16x32_bf16 v[12:15], v[32:35], a[48:51], v[12:15]
  v_mfma_f32_16x16x32_bf16 v[16:19], v[32:35], a[52:55], v[16:19]
  ds_read_b128 v[32:35], v2 offset:448
  s_waitcnt lgkmcnt(3)
  v_mfma_f32_16x16x32_bf16 v[12:15], v[20:23], a[56:59], v[12:15]
  v_mfma_f32_16x16x32_bf16 v[16:19], v[20:23], a[60:63], v[16:19]
  ds_read_b128 v[20:23], v2 offset:512
  s_waitcnt lgkmcnt(3)
  v_mfma_f32_16x16x32_bf16 v[12:15], v[24:27], a[64:67], v[12:15]
  v_mfma_f32_16x16x32_bf16 v[16:19], v[24:27], a[68:71], v[16:19]
  ds_read_b128 v[24:27], v2 offset:576
  s_waitcnt lgkmcnt(3)
  v_mfma_f32_16x16x32_bf16 v[12:15], v[28:31], a[72:75], v[12:15]
  v_mfma_f32_16x16x32_bf16 v[16:19], v[28:31], a[76:79], v[16:19]
  ds_read_b128 v[28:31], v2 offset:640
  s_waitcnt lgkmcnt(3)
  v_mfma_f32_16x16x32_bf16 v[12:15], v[32:35], a[80:83], v[12:15]
  v_mfma_f32_16x16x32_bf16 v[16:19], v[32:35], a[84:87], v[16:19]
  ds_read_b128 v[32:35], v2 offset:704
  s_waitcnt lgkmcnt(3)
  v_mfma_f32_16x16x32_bf16 v[12:15], v[20:23], a[88:91], v[12:15]
  v_mfma_f32_16x16x32_bf16 v[16:19], v[20:23], a[92:95], v[16:19]
  ds_read_b128 v[20:23], v2 offset:768
  s_waitcnt lgkmcnt(3)
  v_mfma_f32_16x16x32_bf16 v[12:15], v[24:27], a[96:99], v[12:15]
  v_mfma_f32_16x16x32_bf16 v[16:19], v[24:27], a[100:103], v[16:19]
  ds_read_b128 v[24:27], v2 offset:832
  s_waitcnt lgkmcnt(3)
  v_mfma_f32_16x16x32_bf16 v[12:15], v[28:31], a[104:107], v[12:15]
  v_mfma_f32_16x16x32_bf16 v[16:19], v[28:31], a[108:111], v[16:19]
  ds_read_b128 v[28:31], v2 offset:896
  s_waitcnt lgkmcnt(3)
  v_mfma_f32_16x16x32_bf16 v[12:15], v[32:35], a[112:115], v[12:15]
  v_mfma_f32_16x16x32_bf16 v[16:19], v[32:35], a[116:119], v[16:19]
  ds_read_b128 v[32:35], v2 offset:960
  s_waitcnt lgkmcnt(3)
  v_mfma_f32_16x16x32_bf16 v[12:15], v[20:23], a[120:123], v[12:15]
  v_mfma_f32_16x16x32_bf16 v[16:19], v[20:23], a[124:127], v[16:19]
  ds_read_b128 v[20:23], v2 offset:1024
  s_waitcnt lgkmcnt(3)
  v_mfma_f32_16x16x32_bf16 v[12:15], v[24:27], a[128:131], v[12:15]
  v_mfma_f32_16x16x32_bf16 v[16:19], v[24:27], a[132:135], v[16:19]
  ds_read_b128 v[24:27], v2 offset:1088
  s_waitcnt lgkmcnt(3)
  v_mfma_f32_16x16x32_bf16 v[12:15], v[28:31], a[136:139], v[12:15]
  v_mfma_f32_16x16x32_bf16 v[16:19], v[28:31], a[140:143], v[16:19]
  s_waitcnt lgkmcnt(2)
  v_mfma_f32_16x16x32_bf16 v[12:15], v[32:35], a[144:147], v[12:15]
  v_mfma_f32_16x16x32_bf16 v[16:19], v[32:35], a[148:151], v[16:19]
  s_waitcnt lgkmcnt(1)
  v_mfma_f32_16x16x32_bf16 v[12:15], v[20:23], a[152:155], v[12:15]
  v_mfma_f32_16x16x32_bf16 v[16:19], v[20:23], a[156:159], v[16:19]
  s_waitcnt lgkmcnt(0)
  v_mfma_f32_16x16x32_bf16 v[12:15], v[24:27], a[160:163], v[12:15]
  v_mfma_f32_16x16x32_bf16 v[16:19], v[24:27], a[164:167], v[16:19]
  s_cmp_eq_u32 s3, 3
  s_nop 5
  s_cbranch_scc0 Lg3_160
  v_lshlrev_b32 v32, 4, v0
  v_add_u32 v32, 133120, v32
  ds_read_b128 v[36:39], v32 offset:0
  ds_read_b128 v[24:27], v2 offset:0
  ds_read_b128 v[40:43], v32 offset:1024
  ds_read_b128 v[28:31], v2 offset:64
  ds_read_b128 v[44:47], v32 offset:2048
  s_waitcnt lgkmcnt(4)
  s_waitcnt lgkmcnt(3)
  v_mfma_f32_16x16x32_bf16 v[20:23], v[24:27], v[36:39], 0
  ds_read_b128 v[24:27], v2 offset:128
  ds_read_b128 v[36:39], v32 offset:3072
  s_waitcnt lgkmcnt(4)
  s_waitcnt lgkmcnt(3)
  v_mfma_f32_16x16x32_bf16 v[20:23], v[28:31], v[40:43], v[20:23]
  ds_read_b128 v[28:31], v2 offset:192
  ds_read_b128 v[40:43], v32 offset:4096
  s_waitcnt lgkmcnt(4)
  s_waitcnt lgkmcnt(3)
  v_mfma_f32_16x16x32_bf16 v[20:23], v[24:27], v[44:47], v[20:23]
  ds_read_b128 v[24:27], v2 offset:256
  ds_read_b128 v[44:47], v32 offset:5120
  s_waitcnt lgkmcnt(4)
  s_waitcnt lgkmcnt(3)
  v_mfma_f32_16x16x32_bf16 v[20:23], v[28:31], v[36:39], v[20:23]
  ds_read_b128 v[28:31], v2 offset:320
  ds_read_b128 v[36:39], v32 offset:6144
  s_waitcnt lgkmcnt(4)
  s_waitcnt lgkmcnt(3)
  v_mfma_f32_16x16x32_bf16 v[20:23], v[24:27], v[40:43], v[20:23]
  ds_read_b128 v[24:27], v2 offset:384
  ds_read_b128 v[40:43], v32 offset:7168
  s_waitcnt lgkmcnt(4)
  s_waitcnt lgkmcnt(3)
  v_mfma_f32_16x16x32_bf16 v[20:23], v[28:31], v[44:47], v[20:23]
  ds_read_b128 v[28:31], v2 offset:448
  ds_read_b128 v[44:47], v32 offset:8192
  s_waitcnt lgkmcnt(4)
  s_waitcnt lgkmcnt(3)
  v_mfma_f32_16x16x32_bf16 v[20:23], v[24:27], v[36:39], v[20:23]
  ds_read_b128 v[24:27], v2 offset:512
  ds_read_b128 v[36:39], v32 offset:9216
  s_waitcnt lgkmcnt(4)
  s_waitcnt lgkmcnt(3)
  v_mfma_f32_16x16x32_bf16 v[20:23], v[28:31], v[40:43], v[20:23]
  ds_read_b128 v[28:31], v2 offset:576
  ds_read_b128 v[40:43], v32 offset:10240
  s_waitcnt lgkmcnt(4)
  s_waitcnt lgkmcnt(3)
  v_mfma_f32_16x16x32_bf16 v[20:23], v[24:27], v[44:47], v[20:23]
  ds_read_b128 v[24:27], v2 offset:640
  ds_read_b128 v[44:47], v32 offset:11264
  s_waitcnt lgkmcnt(4)
  s_waitcnt lgkmcnt(3)
  v_mfma_f32_16x16x32_bf16 v[20:23], v[28:31], v[36:39], v[20:23]
  ds_read_b128 v[28:31], v2 offset:704
  ds_read_b128 v[36:39], v32 offset:12288
  s_waitcnt lgkmcnt(4)
  s_waitcnt lgkmcnt(3)
  v_mfma_f32_16x16x32_bf16 v[20:23], v[24:27], v[40:43], v[20:23]
  ds_read_b128 v[24:27], v2 offset:768
  ds_read_b128 v[40:43], v32 offset:13312
  s_waitcnt lgkmcnt(4)
  s_waitcnt lgkmcnt(3)
  v_mfma_f32_16x16x32_bf16 v[20:23], v[28:31], v[44:47], v[20:23]
  ds_read_b128 v[28:31], v2 offset:832
  ds_read_b128 v[44:47], v32 offset:14336
  s_waitcnt lgkmcnt(4)
  s_waitcnt lgkmcnt(3)
  v_mfma_f32_16x16x32_bf16 v[20:23], v[24:27], v[36:39], v[20:23]
  ds_read_b128 v[24:27], v2 offset:896
  ds_read_b128 v[36:39], v32 offset:15360
  s_waitcnt lgkmcnt(4)
  s_waitcnt lgkmcnt(3)
  v_mfma_f32_16x16x32_bf16 v[20:23], v[28:31], v[40:43], v[20:23]
  ds_read_b128 v[28:31], v2 offset:960
  ds_read_b128 v[40:43], v32 offset:16384
  s_waitcnt lgkmcnt(4)
  s_waitcnt lgkmcnt(3)
  v_mfma_f32_16x16x32_bf16 v[20:23], v[24:27], v[44:47], v[20:23]
  ds_read_b128 v[24:27], v2 offset:1024
  ds_read_b128 v[44:47], v32 offset:17408
  s_waitcnt lgkmcnt(4)
  s_waitcnt lgkmcnt(3)
  v_mfma_f32_16x16x32_bf16 v[20:23], v[28:31], v[36:39], v[20:23]
  ds_read_b128 v[28:31], v2 offset:1088
  s_waitcnt lgkmcnt(3)
  s_waitcnt lgkmcnt(2)
  v_mfma_f32_16x16x32_bf16 v[20:23], v[24:27], v[40:43], v[20:23]
  s_waitcnt lgkmcnt(1)
  s_waitcnt lgkmcnt(0)
  v_mfma_f32_16x16x32_bf16 v[20:23], v[28:31], v[44:47], v[20:23]
Lg3_160:
  v_mov_b32 v4, v12
  v_cndmask_b32 v4, v4, v16, s[60:61]
  s_nop 5
  v_cndmask_b32 v4, v4, v20, s[62:63]
  s_nop 0
  s_branch L_citer
Lodd_90:
  s_cmp_eq_u32 s4, 0
  s_cbranch_scc0 Lno_161
  v_cvt_pk_bf16_f32 v12, v5, v6
  v_cvt_pk_bf16_f32 v13, v7, v8
  v_lshrrev_b32 v14, 1, v1
  s_lshr_b32 s10, s8, 1
  s_mul_i32 s10, s10, 1152
  s_mov_b32 exec_lo, -1
  s_mov_b32 exec_hi, 0xf
  buffer_store_dwordx2 v[12:13], v14, s[52:55], s10 offen
  s_mov_b64 exec, -1
Lno_161:
  s_add_u32 s7, s7, 1
  s_cmp_lt_u32 s7, 6
  s_cbranch_scc1 L_citer
L_exit:
  s_endpgm

.section .rodata,"a"
.p2align 6
.amdhsa_kernel interleave_layers__mha_block_cached__dense_activation_gelu__decode_kernel
  .amdhsa_next_free_vgpr 512
  .amdhsa_next_free_sgpr 102
  .amdhsa_accum_offset 256
  .amdhsa_group_segment_fixed_size 0
  .amdhsa_kernarg_size 104
  .amdhsa_user_sgpr_count 2
  .amdhsa_user_sgpr_kernarg_segment_ptr 1
  .amdhsa_system_sgpr_workgroup_id_x 1
.end_amdhsa_kernel
```
